```python
import torch

def _softmax(x, axis=-1):
    return torch.softmax(x, dim=axis)
def _gelu(x):
    return torch.nn.functional.gelu(x, approximate="tanh")
def _silu(x):
    return torch.nn.functional.silu(x)
def _sigmoid(x):
    return torch.sigmoid(x)
def _layernorm(x, axis=-1, eps=1e-5):
    m = x.mean(dim=axis, keepdim=True)
    v = x.var(dim=axis, keepdim=True, unbiased=False)
    return (x - m) / torch.sqrt(v + eps)
def _scatter_add(tgt, idx, src, axis=0):
    return tgt.clone().index_add_(axis, idx, src)
def _segment_sum(src, seg, n):
    out = torch.zeros((n,) + src.shape[1:], dtype=src.dtype)
    return out.index_add_(0, seg, src)
def _pad(x, pw):
    flat = tuple(v for pair in reversed(pw) for v in pair)
    return torch.nn.functional.pad(x, flat)

kernel_name = 'concat_heads__grouped_kv_mqa__ssm_conv_s4__prompt'

def setup_inputs():

    _w = (lambda a: (lambda t: t.to(torch.bfloat16) if t.is_floating_point() else t)(torch.as_tensor(a)))
    def _A_setup():
        B, S, D, H = 1, 2048, 576, 32
        Dh = D // H
        return {
            "x": _w((lambda *s: torch.randn(*s, dtype=torch.bfloat16) * 0.05)(B, S, D)),
            "wq": _w((lambda *s: torch.randn(*s, dtype=torch.bfloat16) * 0.8)(D, H * Dh)),
            "wk": _w((lambda *s: torch.randn(*s, dtype=torch.bfloat16) * 0.8)(D, Dh)),
            "wv": _w((lambda *s: torch.randn(*s, dtype=torch.bfloat16) * 0.05)(D, Dh)),
            "wo": _w((lambda *s: torch.randn(*s, dtype=torch.bfloat16) * 0.05)(H * Dh, D)),
        }
    _A_in = _A_setup()

    def _B_setup():
        B, L, D, N = 1, 2048, 576, 128
        A_re = -(lambda _x: torch.exp(torch.as_tensor(_x)))((lambda *s: torch.randn(*s, dtype=torch.bfloat16) * 6.4)(D, N))
        A_im = torch.pi * (lambda *s: torch.randn(*s, dtype=torch.bfloat16) * 0.05)(D, N)
        B_re = (lambda *s: torch.randn(*s, dtype=torch.bfloat16) * 0.05)(D, N)
        B_im = (lambda *s: torch.randn(*s, dtype=torch.bfloat16) * 0.05)(D, N)
        C_re = (lambda *s: torch.randn(*s, dtype=torch.bfloat16) * 0.05)(D, N)
        C_im = (lambda *s: torch.randn(*s, dtype=torch.bfloat16) * 0.05)(D, N)
        log_dt = (lambda *s: torch.randn(*s, dtype=torch.bfloat16) * 0.05)(D) * 0.5 - 4.0
        Dskip = (lambda *s: torch.randn(*s, dtype=torch.bfloat16) * 0.05)(D)
        return {
            "u": _w((lambda *s: torch.randn(*s, dtype=torch.bfloat16) * 0.05)(B, L, D)),
            "A_re": _w(A_re),
            "A_im": _w(A_im),
            "B_re": _w(B_re),
            "B_im": _w(B_im),
            "C_re": _w(C_re),
            "C_im": _w(C_im),
            "log_dt": _w(log_dt),
            "Dskip": _w(Dskip),
        }
    _B_in = _B_setup()

    return {
        "A_x": _A_in["x"],
        "A_wq": _A_in["wq"],
        "A_wk": _A_in["wk"],
        "A_wv": _A_in["wv"],
        "A_wo": _A_in["wo"],
        "B_u": _B_in["u"],
        "B_A_re": _B_in["A_re"],
        "B_A_im": _B_in["A_im"],
        "B_B_re": _B_in["B_re"],
        "B_B_im": _B_in["B_im"],
        "B_C_re": _B_in["C_re"],
        "B_C_im": _B_in["C_im"],
        "B_log_dt": _B_in["log_dt"],
        "B_Dskip": _B_in["Dskip"],
    }

def reference(A_x, A_wq, A_wk, A_wv, A_wo, B_u, B_A_re, B_A_im, B_B_re, B_B_im, B_C_re, B_C_im, B_log_dt, B_Dskip):
    def _A_ref(x, wq, wk, wv, wo):
        B, S, D = x.shape
        H = 32
        Dh = D // H
        q = (lambda x, *d: x.permute(*d))((x @ wq).reshape(B, S, H, Dh), 0, 2, 1, 3)
        k = x @ wk
        v = x @ wv
        scores = torch.einsum("bhqd,bkd->bhqk", q, k) * (Dh ** -0.5)
        p = _softmax(scores, axis=-1)
        o = torch.einsum("bhqk,bkd->bhqd", p, v)
        return (lambda x, *d: x.permute(*d))(o, 0, 2, 1, 3).reshape(B, S, H * Dh) @ wo

    def _B_ref(u, A_re, A_im, B_re, B_im, C_re, C_im, log_dt, Dskip):
        Bsz, L, D = u.shape
        dt = torch.exp(log_dt)[:, None]
        A = A_re + 1j * A_im
        Bc = B_re + 1j * B_im
        Cc = C_re + 1j * C_im
        logdA = dt * A
        dB = dt * Bc
        l = (lambda x, dt: x.to(dt))(torch.arange(L), A_re.dtype)
        P = torch.exp(logdA[:, :, None] * l[None, None, :])
        K = torch.einsum("dn,dnl,dn->dl", Cc, P, dB).real
        L2 = 2 * L
        Kp = _pad(K, ((0, 0), (0, L)))
        up = (lambda x, *d: x.permute(*d))(u, 0, 2, 1)
        up = _pad(up, ((0, 0), (0, 0), (0, L)))
        Kf = (lambda x, axes=(-2,-1): torch.fft.rfft2(x.float(), dim=axes))(Kp[:, None, :], axes=(-2, -1))
        Uf = (lambda x, axes=(-2,-1): torch.fft.rfft2(x.float(), dim=axes))(up[:, :, None, :], axes=(-2, -1))
        Yf = Uf * Kf[None, :, :, :]
        y = (lambda x, s, axes=(-2,-1): torch.fft.irfft2(x, s=s, dim=axes).to(torch.bfloat16))(Yf, (1, L2), axes=(-2, -1))[:, :, 0, :L]
        y = (lambda x, *d: x.permute(*d))(y, 0, 2, 1) + u * Dskip[None, None, :]
        return y

    a = _A_ref(A_x, A_wq, A_wk, A_wv, A_wo)
    b = _B_ref(B_u, B_A_re, B_A_im, B_B_re, B_B_im, B_C_re, B_C_im, B_log_dt, B_Dskip)
    return torch.concatenate([a, b], axis=-1)
```

```asm
; @launch grid=(256,1,1) block=(512,1,1) lds=163840
.amdgcn_target "amdgcn-amd-amdhsa--gfx950"
.text
.globl concat_heads__grouped_kv_mqa__ssm_conv_s4__prompt_kernel
.p2align 8
.type concat_heads__grouped_kv_mqa__ssm_conv_s4__prompt_kernel,@function
concat_heads__grouped_kv_mqa__ssm_conv_s4__prompt_kernel:
    s_cmp_ge_u32 s2, 256
    s_cbranch_scc1 K_END
    s_load_dwordx16 s[8:23], s[0:1], 0
    s_load_dwordx16 s[24:39], s[0:1], 64
    s_load_dwordx2 s[40:41], s[0:1], 128
    v_lshrrev_b32 v1, 6, v0
    v_and_b32 v0, 63, v0
    s_and_b32 s4, s2, 31
    v_readfirstlane_b32 s3, v1
    s_lshr_b32 s5, s2, 5
    s_and_b32 s6, s2, 7
    s_lshr_b32 s7, s2, 3
    v_lshlrev_b32 v2, 7, v0
    v_mov_b32 v4, 0
    s_cmp_lg_u32 s3, 0
    s_cbranch_scc1 K_NOPF
    s_getpc_b64 s[60:61]
K_PC:
    s_mul_i32 s62, s7, 768
    v_add_u32 v3, s62, v2
    v_min_u32 v3, K_LAST-K_PC, v3
    s_mov_b64 exec, 63
    global_load_dword v248, v3, s[60:61]
    s_mov_b64 exec, 0xffff
    v_lshlrev_b32 v3, 2, v0
    v_add_u32 v3, 163776, v3
    ds_write_b32 v3, v4
    s_mov_b64 exec, -1
K_NOPF:
    s_lshl_b32 s60, s4, 3
    s_add_u32 s60, s60, s5
    s_lshl_b32 s60, s60, 2
    s_add_u32 s60, s60, s3
    s_sub_u32 s60, s60, 4
    s_mul_i32 s60, s60, 2304
    s_lshr_b32 s61, s7, 1
    s_mul_i32 s61, s61, 1408
    s_xor_b32 s42, s5, s7
    s_andn2_b32 s42, 1, s42
    s_cmp_lt_u32 s3, 4
    s_waitcnt lgkmcnt(0)
    s_cbranch_scc1 K_LO
    v_add_u32 v2, s60, v2
    s_mov_b64 exec, 0x3ffff
    global_load_dword v248, v2, s[8:9]
    s_mov_b64 exec, -1
    s_barrier
    s_branch K_HI
K_LO:
    s_cmp_lg_u32 s3, 2
    s_cbranch_scc1 K_LO2
    s_bitcmp0_b32 s7, 0
    s_cselect_b32 s62, s12, s14
    s_cselect_b32 s63, s13, s15
    v_add_u32 v2, s61, v2
    v_min_u32 v2, 20732, v2
    s_mov_b64 exec, 0x7ff
    global_load_dword v248, v2, s[62:63]
    s_mov_b64 exec, 1
    v_mov_b32 v2, 0x2f000
    global_load_dword v248, v2, s[40:41]
    global_load_dword v248, v4, s[38:39] offset:128
    s_mov_b64 exec, -1
    s_branch K_LO3
K_LO2:
    s_min_u32 s60, s3, 2
    s_lshl_b32 s60, s60, 5
    s_add_u32 s60, s60, s7
    s_mul_i32 s60, s60, 6912
    v_add_u32 v2, s60, v2
    s_lshl_b32 s60, s2, 3
    s_add_u32 s60, s60, s3
    s_cmp_lg_u32 s60, 64
    s_cbranch_scc1 K_LO4
    v_lshlrev_b32 v8, 7, v0
    v_add_u32 v8, 196608, v8
    global_store_dword v8, v4, s[40:41] sc1
    v_add_u32 v8, 8192, v8
    global_store_dword v8, v4, s[40:41] sc1
K_LO4:
    s_mov_b32 exec_hi, 0x3fffff
    global_load_dword v248, v2, s[10:11]
    s_mov_b32 exec_hi, -1
K_LO3:
    s_barrier
    s_branch K_HELP
K_HI:
    s_setprio 2
    s_mov_b32 s44, s8
    s_mov_b32 s45, s9
    s_mov_b32 s46, 2359296
    s_mov_b32 s47, 0x20000
    v_lshrrev_b32 v40, 3, v0
    v_mul_u32_u24 v40, 1152, v40
    v_lshrrev_b32 v42, 4, v0
    v_xor_b32 v42, v42, v0
    v_and_b32 v42, 7, v42
    v_lshl_add_u32 v40, v42, 4, v40
    v_xor_b32 v41, 64, v40
    s_and_b32 s60, s3, 3
    s_xor_b32 s62, s60, s5
    s_and_b32 s63, s62, 1
    s_lshl_b32 s63, s63, 6
    v_xor_b32 v40, s63, v40
    s_lshl_b32 s63, s4, 3
    s_add_u32 s67, s63, s62
    s_mul_i32 s67, s67, 9216
    s_xor_b32 s62, s62, 4
    s_add_u32 s68, s63, s62
    s_mul_i32 s68, s68, 9216
    s_lshl_b32 s69, s60, 10
    v_mov_b32 v41, 163776
    v_mov_b32 v42, 1
    s_and_b32 s95, s5, 4
    s_xor_b32 s95, s95, s3
    s_lshr_b32 s61, s95, 2
    v_bfe_u32 v8, v0, 2, 3
    v_lshrrev_b32 v9, 5, v0
    v_mul_u32_u24 v9, 18, v9
    v_add_u32 v8, v8, v9
    v_mul_u32_u24 v8, 160, v8
    s_mul_i32 s62, s61, 46080
    s_add_u32 s62, s62, 56832
    v_add_u32 v8, s62, v8
    v_lshrrev_b32 v9, 4, v0
    v_mul_u32_u24 v9, 72, v9
    v_bfe_u32 v10, v0, 3, 1
    v_mul_u32_u24 v10, 18, v10
    v_add_u32 v9, v9, v10
    v_bfe_u32 v10, v0, 2, 1
    v_add3_u32 v9, v9, v10, 16
    v_mul_u32_u24 v9, 160, v9
    v_add_u32 v9, s62, v9
    v_and_b32 v10, 3, v0
    v_lshlrev_b32 v10, 3, v10
    v_add_u32 v16, v8, v10
    v_add_u32 v19, v9, v10
    s_and_b32 s60, s95, 3
    s_lshr_b32 s61, s95, 2
    v_and_b32 v4, 15, v0
    v_lshrrev_b32 v5, 5, v0
    v_lshlrev_b32 v6, 11, v5
    v_lshl_add_u32 v6, v4, 4, v6
    v_bfe_u32 v5, v0, 4, 1
    v_lshl_add_u32 v6, v5, 9, v6
    v_lshrrev_b32 v5, 4, v0
    v_add_u32 v5, s5, v5
    v_and_b32 v5, 3, v5
    v_lshlrev_b32 v7, 10, v5
    v_lshl_add_u32 v7, v4, 2, v7
    s_lshr_b32 s62, s60, 1
    s_lshl_b32 s64, s62, 10
    s_and_b32 s63, s60, 1
    s_lshl_b32 s63, s63, 8
    s_add_u32 s64, s64, s63
    s_lshl_b32 s63, s61, 15
    s_add_u32 s64, s64, s63
    s_lshl_b32 s65, s60, 6
    s_lshl_b32 s63, s61, 12
    s_add_u32 s65, s65, s63
    s_add_u32 s65, s65, 65536
    s_add_u32 s62, s5, 0
    s_and_b32 s62, s62, 3
    s_lshl_b32 s62, s62, 13
    s_add_u32 s56, s62, s64
    s_add_u32 s57, s56, 4096
    s_add_u32 s62, s5, 1
    s_and_b32 s62, s62, 3
    s_lshl_b32 s62, s62, 13
    s_add_u32 s58, s62, s64
    s_add_u32 s59, s58, 4096
    s_add_u32 s62, s5, 2
    s_and_b32 s62, s62, 3
    s_lshl_b32 s62, s62, 13
    s_add_u32 s82, s62, s64
    s_add_u32 s83, s82, 4096
    s_add_u32 s62, s5, 3
    s_and_b32 s62, s62, 3
    s_lshl_b32 s62, s62, 13
    s_add_u32 s84, s62, s64
    s_add_u32 s85, s84, 4096
    s_mov_b32 s81, s65
    s_lshl_b32 s60, s95, 4
    v_and_b32 v4, 15, v0
    v_add_u32 v4, s60, v4
    v_mul_u32_u24 v4, 304, v4
    v_lshrrev_b32 v5, 4, v0
    v_lshl_add_u32 v244, v5, 4, v4
    v_mul_u32_u24 v4, 7282, v0
    v_lshrrev_b32 v4, 16, v4
    v_mul_u32_u24 v245, 9, v4
    v_sub_u32 v5, v0, v245
    s_lshl_b32 s60, s3, 3
    v_add_u32 v4, s60, v4
    v_mul_u32_u24 v245, 304, v4
    v_lshl_add_u32 v245, v5, 5, v245
    v_mul_u32_u24 v246, 2304, v4
    v_lshl_add_u32 v246, v5, 4, v246
    s_mul_i32 s60, s4, 147456
    s_mul_i32 s61, s5, 144
    s_add_u32 s79, s60, s61
    s_add_u32 s80, s79, 16128
    s_mov_b32 s48, s36
    s_mov_b32 s49, s37
    s_mov_b32 s50, 4718592
    s_mov_b32 s51, 0x20000
    v_mov_b32 v162, v16
    v_mov_b32 v165, v19
    v_mov_b32 v166, v6
    v_mov_b32 v167, v7
    v_and_b32 v4, 31, v0
    v_lshrrev_b32 v13, 1, v4
    v_lshlrev_b32 v4, 7, v4
    v_lshrrev_b32 v5, 5, v0
    v_xor_b32 v13, v13, v5
    v_and_b32 v13, 7, v13
    v_lshl_add_u32 v4, v13, 4, v4
    v_add_u32 v4, 0, v4
    v_xor_b32 v5, 32, v4
    v_xor_b32 v6, 64, v4
    v_xor_b32 v7, 0x60, v4
    s_and_b32 s62, s5, 3
    s_lshl_b32 s62, s62, 10
    v_xor_b32 v4, s62, v4
    v_xor_b32 v5, s62, v5
    v_xor_b32 v6, s62, v6
    v_xor_b32 v7, s62, v7
    s_and_b32 s60, s3, 3
    s_and_b32 s61, s60, 1
    s_mul_i32 s62, s60, 36
    s_lshl_b32 s63, s61, 2
    s_sub_u32 s62, s62, s63
    s_add_u32 s62, s62, 73728
    v_bfe_u32 v13, v0, 4, 1
    v_and_b32 v14, 3, v0
    v_lshl_add_u32 v13, v13, 2, v14
    v_min_u32 v14, 4, v13
    v_add_u32 v13, 1, v13
    v_lshrrev_b32 v13, 1, v13
    s_cmp_eq_u32 s61, 1
    s_cselect_b64 vcc, -1, 0
    v_bfe_u32 v9, v0, 2, 2
    v_cndmask_b32 v13, v14, v13, vcc
    v_lshrrev_b32 v14, 5, v0
    v_lshl_add_u32 v9, v14, 3, v9
    v_mul_u32_u24 v9, 144, v9
    v_lshl_add_u32 v9, v13, 3, v9
    v_add_u32 v9, s62, v9
    v_mov_b32 v8, v9
    v_mov_b32 v10, 163812
    s_lshl_b32 s62, s60, 2
    s_add_u32 s62, s62, 163824
    v_mov_b32 v11, s62
    v_mov_b32 v12, 1
    v_mov_b32 v48, 0
    v_mov_b32 v49, 0
    v_mov_b32 v50, 0
    v_mov_b32 v51, 0
    v_mov_b32 v52, 0
    v_mov_b32 v53, 0
    v_mov_b32 v54, 0
    v_mov_b32 v55, 0
    v_mov_b32 v56, 0
    v_mov_b32 v57, 0
    v_mov_b32 v58, 0
    v_mov_b32 v59, 0
    v_mov_b32 v60, 0
    v_mov_b32 v61, 0
    v_mov_b32 v62, 0
    v_mov_b32 v63, 0
    v_mov_b32 v64, 0
    v_mov_b32 v65, 0
    v_mov_b32 v66, 0
    v_mov_b32 v67, 0
    v_mov_b32 v68, 0
    v_mov_b32 v69, 0
    v_mov_b32 v70, 0
    v_mov_b32 v71, 0
    v_mov_b32 v72, 0
    v_mov_b32 v73, 0
    v_mov_b32 v74, 0
    v_mov_b32 v75, 0
    v_mov_b32 v76, 0
    v_mov_b32 v77, 0
    v_mov_b32 v78, 0
    v_mov_b32 v79, 0
    s_mov_b32 m0, s69
    s_waitcnt vmcnt(0)
    buffer_load_dwordx4 v40, s[44:47], s67 offen offset:0 lds
    s_add_u32 m0, m0, 8064
    s_nop 0
    buffer_load_dwordx4 v40, s[44:47], s67 offen offset:128 lds
    s_add_u32 m0, m0, 8064
    s_nop 0
    buffer_load_dwordx4 v40, s[44:47], s67 offen offset:256 lds
    s_add_u32 m0, m0, 8064
    s_nop 0
    buffer_load_dwordx4 v40, s[44:47], s67 offen offset:384 lds
    s_add_u32 m0, m0, 8064
    s_nop 0
    buffer_load_dwordx4 v40, s[44:47], s67 offen offset:512 lds
    s_add_u32 m0, m0, 8064
    s_nop 0
    buffer_load_dwordx4 v40, s[44:47], s67 offen offset:640 lds
    s_add_u32 m0, m0, 8064
    s_nop 0
    buffer_load_dwordx4 v40, s[44:47], s67 offen offset:768 lds
    s_add_u32 m0, m0, 8064
    s_nop 0
    buffer_load_dwordx4 v40, s[44:47], s67 offen offset:896 lds
    s_add_u32 m0, m0, 8064
    s_nop 0
    buffer_load_dwordx4 v40, s[44:47], s67 offen offset:1024 lds
    s_add_u32 m0, s69, 4096
    s_mov_b64 exec, 1
    ds_add_u32 v41, v42 offset:4
    s_mov_b64 exec, -1
    v_mov_b32 v254, 163780
    s_mov_b32 s91, 3200000
LW_6:
    ds_read_b32 v255, v254
    s_waitcnt lgkmcnt(0)
    v_readfirstlane_b32 s90, v255
    s_sub_u32 s91, s91, 1
    s_cbranch_scc1 LWD_7
    s_cmp_ge_u32 s90, 4
    s_cbranch_scc1 LWD_7
    s_branch LW_6
LWD_7:
    buffer_load_dwordx4 v40, s[44:47], s68 offen offset:0 lds
    s_add_u32 m0, m0, 8064
    s_nop 0
    buffer_load_dwordx4 v40, s[44:47], s68 offen offset:128 lds
    s_add_u32 m0, m0, 8064
    s_nop 0
    buffer_load_dwordx4 v40, s[44:47], s68 offen offset:256 lds
    s_add_u32 m0, m0, 8064
    s_nop 0
    buffer_load_dwordx4 v40, s[44:47], s68 offen offset:384 lds
    s_add_u32 m0, m0, 8064
    s_nop 0
    buffer_load_dwordx4 v40, s[44:47], s68 offen offset:512 lds
    s_add_u32 m0, m0, 8064
    s_waitcnt vmcnt(5)
    s_mov_b64 exec, 1
    ds_add_u32 v41, v42 offset:40
    s_mov_b64 exec, -1
    buffer_load_dwordx4 v40, s[44:47], s68 offen offset:640 lds
    s_add_u32 m0, m0, 8064
    s_nop 0
    buffer_load_dwordx4 v40, s[44:47], s68 offen offset:768 lds
    s_add_u32 m0, m0, 8064
    s_nop 0
    buffer_load_dwordx4 v40, s[44:47], s68 offen offset:896 lds
    s_add_u32 m0, m0, 8064
    s_nop 0
    buffer_load_dwordx4 v40, s[44:47], s68 offen offset:1024 lds
    s_nop 0
    s_waitcnt vmcnt(0)
    s_mov_b64 exec, 1
    ds_add_u32 v41, v42 offset:32
    s_mov_b64 exec, -1
    v_mov_b32 v254, 163808
    s_mov_b32 s91, 3200000
LW_8:
    ds_read_b32 v255, v254
    s_waitcnt lgkmcnt(0)
    v_readfirstlane_b32 s90, v255
    s_sub_u32 s91, s91, 1
    s_cbranch_scc1 LWD_9
    s_cmp_ge_u32 s90, 4
    s_cbranch_scc1 LWD_9
    s_branch LW_8
LWD_9:
    s_mov_b32 s65, 1
    s_mov_b32 s91, 3200000
GS_10:
    ds_read_b32 v2, v10
    s_waitcnt lgkmcnt(0)
    s_sub_u32 s91, s91, 1
    v_readfirstlane_b32 s90, v2
    s_cbranch_scc1 G0_1
    s_cmp_lt_u32 s90, s65
    s_cbranch_scc1 GS_10
G0_1:
    ds_read_b64_tr_b16 v[112:113], v8 offset:0
    ds_read_b64_tr_b16 v[114:115], v8 offset:576
    ds_read_b128 v[80:83], v4
    ds_read_b128 v[84:87], v4 offset:4096
    ds_read_b64_tr_b16 v[116:117], v8 offset:2304
    ds_read_b64_tr_b16 v[118:119], v8 offset:2880
    ds_read_b128 v[88:91], v5
    ds_read_b128 v[92:95], v5 offset:4096
    ds_read_b64_tr_b16 v[120:121], v8 offset:4608
    ds_read_b64_tr_b16 v[122:123], v8 offset:5184
    ds_read_b128 v[96:99], v6
    ds_read_b128 v[100:103], v6 offset:4096
    s_mov_b32 s64, 1
    s_branch GT_2
GP_3:
    s_mov_b32 s91, 3200000
GS_11:
    ds_read_b32 v2, v10
    s_waitcnt lgkmcnt(0)
    s_sub_u32 s91, s91, 1
    v_readfirstlane_b32 s90, v2
    s_cbranch_scc1 GB_4
    s_cmp_lt_u32 s90, s65
    s_cbranch_scc1 GS_11
    s_branch GB_4
GT_2:
    s_waitcnt lgkmcnt(8)
    v_mfma_f32_32x32x16_bf16 v[48:63], v[112:115], v[80:83], v[48:63]
    s_and_b32 s66, s64, 3
    ds_read_b64_tr_b16 v[124:125], v8 offset:6912
    ds_read_b64_tr_b16 v[126:127], v8 offset:7488
    s_mul_i32 s66, s66, 9216
    v_mfma_f32_32x32x16_bf16 v[64:79], v[112:115], v[84:87], v[64:79]
    s_add_u32 s64, s64, 1
    ds_read_b128 v[104:107], v7
    ds_read_b128 v[108:111], v7 offset:4096
    v_add_u32 v8, s66, v9
    s_mov_b64 exec, 1
    ds_add_u32 v11, v12
    s_mov_b64 exec, -1
    s_waitcnt lgkmcnt(8)
    v_mfma_f32_32x32x16_bf16 v[48:63], v[116:119], v[88:91], v[48:63]
    s_min_u32 s65, s64, 9
    v_readfirstlane_b32 s90, v2
    s_cmp_lt_u32 s90, s65
    s_cbranch_scc1 GP_3
GB_4:
    ds_read_b64_tr_b16 v[112:113], v8 offset:0
    ds_read_b64_tr_b16 v[114:115], v8 offset:576
    v_add_u32 v4, 8192, v4
    v_mfma_f32_32x32x16_bf16 v[64:79], v[116:119], v[92:95], v[64:79]
    ds_read_b128 v[80:83], v4
    ds_read_b128 v[84:87], v4 offset:4096
    s_waitcnt lgkmcnt(8)
    v_mfma_f32_32x32x16_bf16 v[48:63], v[120:123], v[96:99], v[48:63]
    ds_read_b64_tr_b16 v[116:117], v8 offset:2304
    ds_read_b64_tr_b16 v[118:119], v8 offset:2880
    v_add_u32 v5, 8192, v5
    v_mfma_f32_32x32x16_bf16 v[64:79], v[120:123], v[100:103], v[64:79]
    ds_read_b128 v[88:91], v5
    ds_read_b128 v[92:95], v5 offset:4096
    s_waitcnt lgkmcnt(8)
    v_mfma_f32_32x32x16_bf16 v[48:63], v[124:127], v[104:107], v[48:63]
    ds_read_b32 v2, v10
    ds_read_b64_tr_b16 v[120:121], v8 offset:4608
    ds_read_b64_tr_b16 v[122:123], v8 offset:5184
    v_add_u32 v6, 8192, v6
    v_mfma_f32_32x32x16_bf16 v[64:79], v[124:127], v[108:111], v[64:79]
    ds_read_b128 v[96:99], v6
    ds_read_b128 v[100:103], v6 offset:4096
    v_add_u32 v7, 8192, v7
    s_cmp_le_u32 s64, 9
    s_cbranch_scc1 GT_2
    s_mov_b32 s60, 0x3eae1a93
    s_nop 4
    s_cmp_eq_u32 s61, 1
    s_cbranch_scc1 GO_12
    v_pk_mul_f32 v[48:49], v[48:49], s[60:61] op_sel_hi:[1,0]
    v_pk_mul_f32 v[50:51], v[50:51], s[60:61] op_sel_hi:[1,0]
    v_pk_mul_f32 v[52:53], v[52:53], s[60:61] op_sel_hi:[1,0]
    v_pk_mul_f32 v[54:55], v[54:55], s[60:61] op_sel_hi:[1,0]
    v_pk_mul_f32 v[56:57], v[56:57], s[60:61] op_sel_hi:[1,0]
    v_pk_mul_f32 v[64:65], v[64:65], s[60:61] op_sel_hi:[1,0]
    v_pk_mul_f32 v[66:67], v[66:67], s[60:61] op_sel_hi:[1,0]
    v_pk_mul_f32 v[68:69], v[68:69], s[60:61] op_sel_hi:[1,0]
    v_pk_mul_f32 v[70:71], v[70:71], s[60:61] op_sel_hi:[1,0]
    v_pk_mul_f32 v[72:73], v[72:73], s[60:61] op_sel_hi:[1,0]
    v_cvt_pk_bf16_f32 v16, v48, v49
    v_cvt_pk_bf16_f32 v17, v50, v51
    v_cvt_pk_bf16_f32 v18, v52, v53
    v_cvt_pk_bf16_f32 v19, v54, v55
    v_cvt_pk_bf16_f32 v13, v56, v57
    v_cvt_pk_bf16_f32 v20, v64, v65
    v_cvt_pk_bf16_f32 v21, v66, v67
    v_cvt_pk_bf16_f32 v22, v68, v69
    v_cvt_pk_bf16_f32 v23, v70, v71
    v_cvt_pk_bf16_f32 v24, v72, v73
    s_branch GJ_13
GO_12:
    v_pk_mul_f32 v[50:51], v[50:51], s[60:61] op_sel_hi:[1,0]
    v_pk_mul_f32 v[52:53], v[52:53], s[60:61] op_sel_hi:[1,0]
    v_pk_mul_f32 v[58:59], v[58:59], s[60:61] op_sel_hi:[1,0]
    v_pk_mul_f32 v[60:61], v[60:61], s[60:61] op_sel_hi:[1,0]
    v_pk_mul_f32 v[62:63], v[62:63], s[60:61] op_sel_hi:[1,0]
    v_pk_mul_f32 v[66:67], v[66:67], s[60:61] op_sel_hi:[1,0]
    v_pk_mul_f32 v[68:69], v[68:69], s[60:61] op_sel_hi:[1,0]
    v_pk_mul_f32 v[74:75], v[74:75], s[60:61] op_sel_hi:[1,0]
    v_pk_mul_f32 v[76:77], v[76:77], s[60:61] op_sel_hi:[1,0]
    v_pk_mul_f32 v[78:79], v[78:79], s[60:61] op_sel_hi:[1,0]
    v_cvt_pk_bf16_f32 v16, v50, v51
    v_cvt_pk_bf16_f32 v17, v52, v53
    v_cvt_pk_bf16_f32 v18, v58, v59
    v_cvt_pk_bf16_f32 v19, v60, v61
    v_cvt_pk_bf16_f32 v13, v62, v63
    v_cvt_pk_bf16_f32 v20, v66, v67
    v_cvt_pk_bf16_f32 v21, v68, v69
    v_cvt_pk_bf16_f32 v22, v74, v75
    v_cvt_pk_bf16_f32 v23, v76, v77
    v_cvt_pk_bf16_f32 v24, v78, v79
GJ_13:
    s_waitcnt lgkmcnt(0)
    s_nop 0
    v_permlane32_swap_b32 v13, v24
    s_add_u32 s52, s40, 0
    s_addc_u32 s53, s41, 0
    s_mov_b32 s54, 151552
    s_mov_b32 s55, 0x20000
    s_and_b32 s76, s3, 3
    s_mul_i32 s76, s76, 4736
    s_add_u32 s78, s76, 56832
    s_add_u32 s76, s76, 37888
    s_mov_b32 s77, s76
    v_lshlrev_b32 v26, 4, v0
    s_mul_i32 s60, s4, 73728
    s_add_u32 s60, s60, 2621440
    s_add_u32 s44, s40, s60
    s_addc_u32 s45, s41, 0
    s_mov_b32 s46, 73728
    s_mov_b32 s47, 0x20000
    s_and_b32 s60, s3, 3
    s_lshl_b32 s86, s5, 2
    s_add_u32 s86, s86, s60
    s_lshl_b32 s86, s86, 11
    s_lshr_b32 s88, s86, 3
    s_add_u32 s88, s88, 65536
    s_lshr_b32 s60, s5, 2
    s_lshl_b32 s87, s60, 10
    s_add_u32 s86, s86, s87
    s_xor_b32 s87, s86, 1024
    s_lshl_b32 s60, s60, 7
    v_lshlrev_b32 v27, 2, v0
    v_xor_b32 v27, s60, v27
    v_mov_b32 v4, -1
    v_mov_b32 v5, -1
    v_mov_b32 v6, -1
    v_mov_b32 v7, -1
    buffer_store_dwordx4 v[4:7], v26, s[44:47], s86 offen sc1
    buffer_store_dwordx4 v[4:7], v26, s[44:47], s87 offen sc1
    buffer_store_dword v4, v27, s[44:47], s88 offen sc1
    s_lshl_b32 s60, s4, 10
    s_lshl_b32 s61, s5, 2
    s_add_u32 s60, s60, s61
    s_add_u32 s60, s60, 229376
    v_lshl_add_u32 v168, v0, 7, s60
    s_getreg_b32 s61, hwreg(HW_REG_XCC_ID, 0, 8)
    s_add_u32 s61, s61, 2
    v_mov_b32 v8, s61
    s_cmp_lg_u32 s3, 7
    s_cbranch_scc1 MB_14
    s_mov_b64 exec, 0xff
    global_store_dword v168, v4, s[40:41] sc1
    s_mov_b64 exec, -1
MB_14:
    s_cmp_lg_u32 s3, 7
    s_cbranch_scc1 MB_15
    s_mov_b64 exec, 0xff
    global_store_dword v168, v8, s[40:41] offset:32 sc1
    s_mov_b64 exec, -1
MB_15:
    v_mov_b32 v28, 0xdddddddd
    v_lshlrev_b32 v29, 4, v0
    v_lshlrev_b32 v30, 2, v0
    v_and_b32 v2, 31, v0
    v_lshrrev_b32 v3, 5, v0
    v_mul_u32_u24 v3, 304, v3
    v_lshl_add_u32 v31, v2, 4, v3
    v_cmp_lt_u32 vcc, 18, v2
    v_mov_b32 v3, 0x100000
    v_mov_b32 v15, 163788
    v_cndmask_b32 v31, v31, v3, vcc
    v_mov_b32 v37, 0x3f80
    v_mov_b32 v157, 0x3f80
    v_mov_b32 v25, 0
    v_mov_b32 v38, 1
    v_mov_b32 v254, 163788
    s_mov_b32 s91, 3200000
LW_16:
    ds_read_b32 v255, v254
    s_waitcnt lgkmcnt(0)
    v_readfirstlane_b32 s90, v255
    s_sub_u32 s91, s91, 1
    s_cbranch_scc1 LWD_17
    s_cmp_ge_u32 s90, 1
    s_cbranch_scc1 LWD_17
    s_branch LW_16
LWD_17:
    ds_read_b32 v36, v30 offset:4096
    ds_read_b128 v[32:35], v29 offset:0
    ds_read_b128 v[144:147], v29 offset:1024
    ds_read_b32 v156, v30 offset:4352
    ds_read_b128 v[40:43], v31 offset:4608
    ds_read_b128 v[44:47], v31 offset:5216
    ds_read_b128 v[148:151], v31 offset:5824
    ds_read_b128 v[152:155], v31 offset:6432
    s_waitcnt lgkmcnt(6)
    v_mfma_f32_32x32x4_2b_bf16 v[80:111], v[36:37], v[24:25], 0 cbsz:1 abid:0
    v_mov_b32 v48, 0
    v_mov_b32 v49, 0
    v_mov_b32 v50, 0
    v_mov_b32 v51, 0
    v_mov_b32 v52, 0
    v_mov_b32 v53, 0
    v_mov_b32 v54, 0
    v_mov_b32 v55, 0
    v_mov_b32 v56, 0
    v_mov_b32 v57, 0
    v_mov_b32 v58, 0
    v_mov_b32 v59, 0
    v_mov_b32 v60, 0
    v_mov_b32 v61, 0
    v_mov_b32 v62, 0
    v_mov_b32 v63, 0
    v_mov_b32 v64, 0
    v_mov_b32 v65, 0
    v_mfma_f32_32x32x16_bf16 v[80:95], v[32:35], v[16:19], v[80:95]
    v_mfma_f32_32x32x16_bf16 v[96:111], v[32:35], v[20:23], v[96:111]
    v_mov_b32 v66, 0
    v_mov_b32 v67, 0
    v_mov_b32 v68, 0
    v_mov_b32 v69, 0
    v_mov_b32 v70, 0
    v_mov_b32 v71, 0
    v_mov_b32 v72, 0
    v_mov_b32 v73, 0
    v_mov_b32 v74, 0
    v_mov_b32 v75, 0
    v_mov_b32 v76, 0
    v_mov_b32 v77, 0
    v_mov_b32 v78, 0
    v_mov_b32 v79, 0
    v_max3_f32 v2, v80, v81, v82
    v_max3_f32 v2, v83, v84, v2
    v_max3_f32 v2, v85, v86, v2
    v_max3_f32 v2, v87, v88, v2
    v_max3_f32 v2, v89, v90, v2
    v_max3_f32 v2, v91, v92, v2
    v_max3_f32 v2, v93, v94, v2
    v_max_f32 v2, v95, v2
    v_max3_f32 v3, v96, v97, v98
    v_max3_f32 v3, v99, v100, v3
    v_max3_f32 v3, v101, v102, v3
    v_max3_f32 v3, v103, v104, v3
    v_max3_f32 v3, v105, v106, v3
    v_max3_f32 v3, v107, v108, v3
    v_max3_f32 v3, v109, v110, v3
    v_max_f32 v3, v111, v3
    s_nop 1
    v_permlane32_swap_b32 v2, v3
    v_max_f32 v2, v2, v3
    v_cvt_pk_bf16_f32 v25, -v2, 0
    s_nop 1
    v_mfma_f32_32x32x4_2b_bf16 v[80:111], v[36:37], v[24:25], 0 cbsz:1 abid:0
    v_mov_b32 v136, 0
    v_mov_b32 v137, 0
    v_mov_b32 v138, 0
    v_mov_b32 v139, 0
    v_mov_b32 v140, 0
    v_mov_b32 v141, 0
    v_mov_b32 v142, 0
    v_mov_b32 v143, 0
    s_mov_b32 s70, 0
    s_mov_b32 s73, 4294929408
    s_mov_b32 s72, 6
    s_nop 6
    v_mfma_f32_32x32x16_bf16 v[80:95], v[32:35], v[16:19], v[80:95]
    v_mfma_f32_32x32x16_bf16 v[96:111], v[32:35], v[20:23], v[96:111]
    s_waitcnt lgkmcnt(0)
    ds_read_b128 v[32:35], v29 offset:2048
    s_nop 8
.p2align 6
AL_18:
    v_exp_f32 v80, v80
    v_exp_f32 v81, v81
    v_smfmac_f32_32x32x32_bf16 v[64:79], v[152:155], v[136:143], v28
    s_waitcnt lgkmcnt(2)
    s_add_u32 s70, s70, 1
    ds_read_b128 v[152:155], v31 offset:6432
    v_exp_f32 v82, v82
    v_exp_f32 v83, v83
    v_exp_f32 v84, v84
    v_exp_f32 v85, v85
    v_mfma_f32_32x32x4_2b_bf16 v[112:143], v[36:37], v[24:25], 0 cbsz:1 abid:1
    v_exp_f32 v86, v86
    v_exp_f32 v87, v87
    v_exp_f32 v88, v88
    v_exp_f32 v89, v89
    v_exp_f32 v90, v90
    v_exp_f32 v91, v91
    v_exp_f32 v92, v92
    v_exp_f32 v93, v93
    v_smfmac_f32_32x32x32_bf16 v[48:63], v[40:43], v[80:87], v28
    ds_read_b32 v36, v30 offset:13568
    v_exp_f32 v94, v94
    v_exp_f32 v95, v95
    v_exp_f32 v96, v96
    v_exp_f32 v97, v97
    v_smfmac_f32_32x32x32_bf16 v[48:63], v[44:47], v[88:95], v28
    s_cmp_eq_u32 s70, 3
    s_cselect_b32 s71, s73, 18944
    v_exp_f32 v98, v98
    v_exp_f32 v99, v99
    v_exp_f32 v100, v100
    v_exp_f32 v101, v101
    v_mfma_f32_32x32x16_bf16 v[112:127], v[144:147], v[16:19], v[112:127]
    v_exp_f32 v102, v102
    v_exp_f32 v103, v103
    v_exp_f32 v104, v104
    v_exp_f32 v105, v105
    v_smfmac_f32_32x32x32_bf16 v[64:79], v[40:43], v[96:103], v28
    ds_read_b128 v[40:43], v31 offset:7040
    v_exp_f32 v106, v106
    v_exp_f32 v107, v107
    v_exp_f32 v108, v108
    v_exp_f32 v109, v109
    v_mfma_f32_32x32x16_bf16 v[128:143], v[144:147], v[20:23], v[128:143]
    ds_read_b128 v[144:147], v29 offset:3072
    v_exp_f32 v110, v110
    v_exp_f32 v111, v111
    v_exp_f32 v112, v112
    v_exp_f32 v113, v113
    v_smfmac_f32_32x32x32_bf16 v[64:79], v[44:47], v[104:111], v28
    s_waitcnt lgkmcnt(3)
    ds_read_b128 v[44:47], v31 offset:7648
    v_exp_f32 v114, v114
    v_exp_f32 v115, v115
    v_exp_f32 v116, v116
    v_exp_f32 v117, v117
    v_mfma_f32_32x32x4_2b_bf16 v[80:111], v[156:157], v[24:25], 0 cbsz:1 abid:0
    v_exp_f32 v118, v118
    v_exp_f32 v119, v119
    v_exp_f32 v120, v120
    v_exp_f32 v121, v121
    v_exp_f32 v122, v122
    v_exp_f32 v123, v123
    v_exp_f32 v124, v124
    v_exp_f32 v125, v125
    v_smfmac_f32_32x32x32_bf16 v[48:63], v[148:151], v[112:119], v28
    s_cmp_eq_u32 s77, s78
    s_cselect_b32 s61, 56832, 0
    v_exp_f32 v126, v126
    v_exp_f32 v127, v127
    v_exp_f32 v128, v128
    v_exp_f32 v129, v129
    v_smfmac_f32_32x32x32_bf16 v[48:63], v[152:155], v[120:127], v28
    s_cmp_eq_u32 s70, 6
    s_cselect_b32 s71, s73, s71
    v_exp_f32 v130, v130
    v_exp_f32 v131, v131
    v_exp_f32 v132, v132
    v_exp_f32 v133, v133
    v_mfma_f32_32x32x16_bf16 v[80:95], v[32:35], v[16:19], v[80:95]
    v_exp_f32 v134, v134
    v_exp_f32 v135, v135
    v_exp_f32 v136, v136
    v_exp_f32 v137, v137
    v_smfmac_f32_32x32x32_bf16 v[64:79], v[148:151], v[128:135], v28
    ds_read_b128 v[148:151], v31 offset:8256
    v_exp_f32 v138, v138
    v_exp_f32 v139, v139
    v_exp_f32 v140, v140
    v_exp_f32 v141, v141
    v_mfma_f32_32x32x16_bf16 v[96:111], v[32:35], v[20:23], v[96:111]
    ds_read_b128 v[32:35], v29 offset:9472
    v_exp_f32 v142, v142
    v_exp_f32 v143, v143
    v_exp_f32 v80, v80
    v_exp_f32 v81, v81
    v_smfmac_f32_32x32x32_bf16 v[64:79], v[152:155], v[136:143], v28
    s_waitcnt lgkmcnt(2)
    ds_read_b128 v[152:155], v31 offset:8864
    v_exp_f32 v82, v82
    v_exp_f32 v83, v83
    v_exp_f32 v84, v84
    v_exp_f32 v85, v85
    v_mfma_f32_32x32x4_2b_bf16 v[112:143], v[156:157], v[24:25], 0 cbsz:1 abid:1
    v_exp_f32 v86, v86
    v_exp_f32 v87, v87
    v_exp_f32 v88, v88
    v_exp_f32 v89, v89
    v_exp_f32 v90, v90
    v_exp_f32 v91, v91
    v_exp_f32 v92, v92
    v_exp_f32 v93, v93
    v_smfmac_f32_32x32x32_bf16 v[48:63], v[40:43], v[80:87], v28
    ds_read_b32 v156, v30 offset:13824
    v_exp_f32 v94, v94
    v_exp_f32 v95, v95
    v_exp_f32 v96, v96
    v_exp_f32 v97, v97
    v_smfmac_f32_32x32x32_bf16 v[48:63], v[44:47], v[88:95], v28
    s_waitcnt vmcnt(0)
    s_mov_b64 exec, 1
    ds_add_u32 v15, v38
    s_mov_b64 exec, -1
    v_exp_f32 v98, v98
    v_exp_f32 v99, v99
    v_exp_f32 v100, v100
    v_exp_f32 v101, v101
    v_mfma_f32_32x32x16_bf16 v[112:127], v[144:147], v[16:19], v[112:127]
    v_exp_f32 v102, v102
    v_exp_f32 v103, v103
    v_exp_f32 v104, v104
    v_exp_f32 v105, v105
    v_smfmac_f32_32x32x32_bf16 v[64:79], v[40:43], v[96:103], v28
    ds_read_b128 v[40:43], v31 offset:14080
    v_exp_f32 v106, v106
    v_exp_f32 v107, v107
    v_exp_f32 v108, v108
    v_exp_f32 v109, v109
    v_mfma_f32_32x32x16_bf16 v[128:143], v[144:147], v[20:23], v[128:143]
    ds_read_b128 v[144:147], v29 offset:10496
    v_exp_f32 v110, v110
    v_exp_f32 v111, v111
    v_exp_f32 v112, v112
    v_exp_f32 v113, v113
    v_smfmac_f32_32x32x32_bf16 v[64:79], v[44:47], v[104:111], v28
    s_waitcnt lgkmcnt(2)
    ds_read_b128 v[44:47], v31 offset:14688
    v_exp_f32 v114, v114
    v_exp_f32 v115, v115
    v_exp_f32 v116, v116
    v_exp_f32 v117, v117
    v_mfma_f32_32x32x4_2b_bf16 v[80:111], v[36:37], v[24:25], 0 cbsz:1 abid:0
    v_exp_f32 v118, v118
    v_exp_f32 v119, v119
    v_exp_f32 v120, v120
    v_exp_f32 v121, v121
    v_exp_f32 v122, v122
    v_exp_f32 v123, v123
    v_exp_f32 v124, v124
    v_exp_f32 v125, v125
    v_smfmac_f32_32x32x32_bf16 v[48:63], v[148:151], v[112:119], v28
    s_sub_u32 s77, s77, s61
    s_mov_b32 m0, s77
    v_exp_f32 v126, v126
    v_exp_f32 v127, v127
    v_exp_f32 v128, v128
    v_exp_f32 v129, v129
    v_smfmac_f32_32x32x32_bf16 v[48:63], v[152:155], v[120:127], v28
    ds_read_b32 v39, v15
    v_exp_f32 v130, v130
    v_exp_f32 v131, v131
    v_exp_f32 v132, v132
    v_exp_f32 v133, v133
    v_mfma_f32_32x32x16_bf16 v[80:95], v[32:35], v[16:19], v[80:95]
    v_exp_f32 v134, v134
    v_exp_f32 v135, v135
    v_exp_f32 v136, v136
    v_exp_f32 v137, v137
    v_smfmac_f32_32x32x32_bf16 v[64:79], v[148:151], v[128:135], v28
    ds_read_b128 v[148:151], v31 offset:15296
    v_exp_f32 v138, v138
    v_exp_f32 v139, v139
    v_exp_f32 v140, v140
    v_exp_f32 v141, v141
    v_mfma_f32_32x32x16_bf16 v[96:111], v[32:35], v[20:23], v[96:111]
    ds_read_b128 v[32:35], v29 offset:11520
    v_exp_f32 v142, v142
    v_exp_f32 v143, v143
    v_exp_f32 v80, v80
    v_exp_f32 v81, v81
    v_smfmac_f32_32x32x32_bf16 v[64:79], v[152:155], v[136:143], v28
    s_waitcnt lgkmcnt(2)
    ds_read_b128 v[152:155], v31 offset:15904
    v_readfirstlane_b32 s60, v39
    v_exp_f32 v82, v82
    v_exp_f32 v83, v83
    v_exp_f32 v84, v84
    v_exp_f32 v85, v85
    v_mfma_f32_32x32x4_2b_bf16 v[112:143], v[36:37], v[24:25], 0 cbsz:1 abid:1
    v_add_u32 v30, s71, v30
    v_exp_f32 v86, v86
    v_exp_f32 v87, v87
    v_exp_f32 v88, v88
    v_exp_f32 v89, v89
    v_exp_f32 v90, v90
    v_exp_f32 v91, v91
    v_exp_f32 v92, v92
    v_exp_f32 v93, v93
    v_smfmac_f32_32x32x32_bf16 v[48:63], v[40:43], v[80:87], v28
    s_cmp_lt_u32 s60, s72
    s_cbranch_scc1 AC_19
AK_20:
    ds_read_b32 v36, v30 offset:4096
    v_exp_f32 v94, v94
    v_exp_f32 v95, v95
    v_exp_f32 v96, v96
    v_exp_f32 v97, v97
    v_smfmac_f32_32x32x32_bf16 v[48:63], v[44:47], v[88:95], v28
    s_add_u32 s72, s72, 4
    buffer_load_dwordx4 v26, s[52:55], s76 offen offset:0 sc1 lds
    v_exp_f32 v98, v98
    v_exp_f32 v99, v99
    v_exp_f32 v100, v100
    v_exp_f32 v101, v101
    v_mfma_f32_32x32x16_bf16 v[112:127], v[144:147], v[16:19], v[112:127]
    v_exp_f32 v102, v102
    v_exp_f32 v103, v103
    v_exp_f32 v104, v104
    v_exp_f32 v105, v105
    v_smfmac_f32_32x32x32_bf16 v[64:79], v[40:43], v[96:103], v28
    ds_read_b128 v[40:43], v31 offset:16512
    v_exp_f32 v106, v106
    v_exp_f32 v107, v107
    v_exp_f32 v108, v108
    v_exp_f32 v109, v109
    v_mfma_f32_32x32x16_bf16 v[128:143], v[144:147], v[20:23], v[128:143]
    ds_read_b128 v[144:147], v29 offset:12544
    v_exp_f32 v110, v110
    v_exp_f32 v111, v111
    v_exp_f32 v112, v112
    v_exp_f32 v113, v113
    v_smfmac_f32_32x32x32_bf16 v[64:79], v[44:47], v[104:111], v28
    s_waitcnt lgkmcnt(3)
    ds_read_b128 v[44:47], v31 offset:17120
    v_exp_f32 v114, v114
    v_exp_f32 v115, v115
    v_exp_f32 v116, v116
    v_exp_f32 v117, v117
    v_mfma_f32_32x32x4_2b_bf16 v[80:111], v[156:157], v[24:25], 0 cbsz:1 abid:0
    v_exp_f32 v118, v118
    v_exp_f32 v119, v119
    v_exp_f32 v120, v120
    v_exp_f32 v121, v121
    v_exp_f32 v122, v122
    v_exp_f32 v123, v123
    v_exp_f32 v124, v124
    v_exp_f32 v125, v125
    v_smfmac_f32_32x32x32_bf16 v[48:63], v[148:151], v[112:119], v28
    buffer_load_dwordx4 v26, s[52:55], s76 offen offset:1024 sc1 lds
    v_exp_f32 v126, v126
    v_exp_f32 v127, v127
    v_exp_f32 v128, v128
    v_exp_f32 v129, v129
    v_smfmac_f32_32x32x32_bf16 v[48:63], v[152:155], v[120:127], v28
    buffer_load_dwordx4 v26, s[52:55], s76 offen offset:2048 sc1 lds
    v_exp_f32 v130, v130
    v_exp_f32 v131, v131
    v_exp_f32 v132, v132
    v_exp_f32 v133, v133
    v_mfma_f32_32x32x16_bf16 v[80:95], v[32:35], v[16:19], v[80:95]
    v_add_u32 v29, s71, v29
    v_exp_f32 v134, v134
    v_exp_f32 v135, v135
    v_exp_f32 v136, v136
    v_exp_f32 v137, v137
    v_smfmac_f32_32x32x32_bf16 v[64:79], v[148:151], v[128:135], v28
    ds_read_b128 v[148:151], v31 offset:17728
    v_exp_f32 v138, v138
    v_exp_f32 v139, v139
    v_exp_f32 v140, v140
    v_exp_f32 v141, v141
    v_mfma_f32_32x32x16_bf16 v[96:111], v[32:35], v[20:23], v[96:111]
    ds_read_b128 v[32:35], v29 offset:0
    v_exp_f32 v142, v142
    v_exp_f32 v143, v143
    v_exp_f32 v80, v80
    v_exp_f32 v81, v81
    v_smfmac_f32_32x32x32_bf16 v[64:79], v[152:155], v[136:143], v28
    s_waitcnt lgkmcnt(2)
    ds_read_b128 v[152:155], v31 offset:18336
    v_exp_f32 v82, v82
    v_exp_f32 v83, v83
    v_exp_f32 v84, v84
    v_exp_f32 v85, v85
    v_mfma_f32_32x32x4_2b_bf16 v[112:143], v[156:157], v[24:25], 0 cbsz:1 abid:1
    v_exp_f32 v86, v86
    v_exp_f32 v87, v87
    v_exp_f32 v88, v88
    v_exp_f32 v89, v89
    v_exp_f32 v90, v90
    v_exp_f32 v91, v91
    v_exp_f32 v92, v92
    v_exp_f32 v93, v93
    v_smfmac_f32_32x32x32_bf16 v[48:63], v[40:43], v[80:87], v28
    ds_read_b32 v156, v30 offset:4352
    v_exp_f32 v94, v94
    v_exp_f32 v95, v95
    v_exp_f32 v96, v96
    v_exp_f32 v97, v97
    v_smfmac_f32_32x32x32_bf16 v[48:63], v[44:47], v[88:95], v28
    buffer_load_dwordx4 v26, s[52:55], s76 offen offset:3072 sc1 lds
    v_exp_f32 v98, v98
    v_exp_f32 v99, v99
    v_exp_f32 v100, v100
    v_exp_f32 v101, v101
    v_mfma_f32_32x32x16_bf16 v[112:127], v[144:147], v[16:19], v[112:127]
    v_add_u32 v31, s71, v31
    v_exp_f32 v102, v102
    v_exp_f32 v103, v103
    v_exp_f32 v104, v104
    v_exp_f32 v105, v105
    v_smfmac_f32_32x32x32_bf16 v[64:79], v[40:43], v[96:103], v28
    ds_read_b128 v[40:43], v31 offset:4608
    v_exp_f32 v106, v106
    v_exp_f32 v107, v107
    v_exp_f32 v108, v108
    v_exp_f32 v109, v109
    v_mfma_f32_32x32x16_bf16 v[128:143], v[144:147], v[20:23], v[128:143]
    ds_read_b128 v[144:147], v29 offset:1024
    v_exp_f32 v110, v110
    v_exp_f32 v111, v111
    v_exp_f32 v112, v112
    v_exp_f32 v113, v113
    v_smfmac_f32_32x32x32_bf16 v[64:79], v[44:47], v[104:111], v28
    s_waitcnt lgkmcnt(3)
    ds_read_b128 v[44:47], v31 offset:5216
    v_exp_f32 v114, v114
    v_exp_f32 v115, v115
    v_exp_f32 v116, v116
    v_exp_f32 v117, v117
    v_mfma_f32_32x32x4_2b_bf16 v[80:111], v[36:37], v[24:25], 0 cbsz:1 abid:0
    v_exp_f32 v118, v118
    v_exp_f32 v119, v119
    v_exp_f32 v120, v120
    v_exp_f32 v121, v121
    v_exp_f32 v122, v122
    v_exp_f32 v123, v123
    v_exp_f32 v124, v124
    v_exp_f32 v125, v125
    v_smfmac_f32_32x32x32_bf16 v[48:63], v[148:151], v[112:119], v28
    buffer_load_dwordx4 v26, s[52:55], s76 offen offset:3712 sc1 lds
    v_exp_f32 v126, v126
    v_exp_f32 v127, v127
    v_exp_f32 v128, v128
    v_exp_f32 v129, v129
    v_smfmac_f32_32x32x32_bf16 v[48:63], v[152:155], v[120:127], v28
    s_add_u32 s76, s76, 18944
    s_add_u32 s77, s77, 18944
    v_exp_f32 v130, v130
    v_exp_f32 v131, v131
    v_exp_f32 v132, v132
    v_exp_f32 v133, v133
    v_mfma_f32_32x32x16_bf16 v[80:95], v[32:35], v[16:19], v[80:95]
    v_exp_f32 v134, v134
    v_exp_f32 v135, v135
    v_exp_f32 v136, v136
    v_exp_f32 v137, v137
    v_smfmac_f32_32x32x32_bf16 v[64:79], v[148:151], v[128:135], v28
    ds_read_b128 v[148:151], v31 offset:5824
    v_exp_f32 v138, v138
    v_exp_f32 v139, v139
    v_exp_f32 v140, v140
    v_exp_f32 v141, v141
    v_mfma_f32_32x32x16_bf16 v[96:111], v[32:35], v[20:23], v[96:111]
    s_cmp_lg_u32 s70, 8
    ds_read_b128 v[32:35], v29 offset:2048
    v_exp_f32 v142, v142
    v_exp_f32 v143, v143
    s_cbranch_scc1 AL_18
    s_nop 0
    v_smfmac_f32_32x32x32_bf16 v[64:79], v[152:155], v[136:143], v28
    s_barrier
    ds_read_b32 v39, v15 offset:4
    s_mov_b32 s62, 0
ALC_22:
    s_mov_b32 s60, 0x4e800000
    s_mov_b32 s61, 0x21800000
    s_nop 8
    v_mov_b32 v2, v58
    v_mov_b32 v4, v58
    v_mov_b32 v3, v74
    v_mov_b32 v5, v74
    s_nop 1
    v_permlane32_swap_b32 v2, v4
    v_permlane32_swap_b32 v3, v5
    v_cmp_ngt_f32 vcc, s60, v2
    v_cmp_ngt_f32 s[64:65], s60, v3
    v_cmp_nlt_f32 s[66:67], s61, v2
    v_cmp_nlt_f32 s[68:69], s61, v3
    s_or_b64 vcc, vcc, s[64:65]
    s_or_b64 s[66:67], s[66:67], s[68:69]
    s_or_b64 vcc, vcc, s[66:67]
    s_cbranch_scc0 AD_21
    s_cmp_lg_u32 s62, 0
    s_cbranch_scc1 AD_21
    s_branch ATT_SLOW
AD_21:
    v_rcp_f32 v2, v2
    v_rcp_f32 v3, v3
    v_mul_f32 v48, v48, v2
    v_mul_f32 v49, v49, v2
    v_mul_f32 v50, v50, v2
    v_mul_f32 v51, v51, v2
    v_mul_f32 v52, v52, v2
    v_mul_f32 v53, v53, v2
    v_mul_f32 v54, v54, v2
    v_mul_f32 v55, v55, v2
    v_mul_f32 v56, v56, v2
    v_mul_f32 v57, v57, v2
    v_cvt_pk_bf16_f32 v4, v48, v49
    v_cvt_pk_bf16_f32 v5, v50, v51
    v_cvt_pk_bf16_f32 v6, v52, v53
    v_cvt_pk_bf16_f32 v7, v54, v55
    v_cvt_pk_bf16_f32 v12, v56, v57
    v_min_u32 v4, -2, v4
    v_min_u32 v5, -2, v5
    v_min_u32 v6, -2, v6
    v_min_u32 v7, -2, v7
    v_mul_f32 v64, v64, v3
    v_mul_f32 v65, v65, v3
    v_mul_f32 v66, v66, v3
    v_mul_f32 v67, v67, v3
    v_mul_f32 v68, v68, v3
    v_mul_f32 v69, v69, v3
    v_mul_f32 v70, v70, v3
    v_mul_f32 v71, v71, v3
    v_mul_f32 v72, v72, v3
    v_mul_f32 v73, v73, v3
    v_cvt_pk_bf16_f32 v8, v64, v65
    v_cvt_pk_bf16_f32 v9, v66, v67
    v_cvt_pk_bf16_f32 v10, v68, v69
    v_cvt_pk_bf16_f32 v11, v70, v71
    v_cvt_pk_bf16_f32 v13, v72, v73
    v_min_u32 v8, -2, v8
    v_min_u32 v9, -2, v9
    v_min_u32 v10, -2, v10
    v_min_u32 v11, -2, v11
    s_waitcnt lgkmcnt(0)
    v_readfirstlane_b32 s60, v39
    v_permlane32_swap_b32 v12, v13
    v_min_u32 v12, -2, v12
    s_cmp_lg_u32 s60, 1
    s_cbranch_scc1 OF_124
    buffer_store_dwordx4 v[4:7], v26, s[44:47], s86 offen
    buffer_store_dwordx4 v[8:11], v26, s[44:47], s87 offen
    buffer_store_dword v12, v27, s[44:47], s88 offen
    s_cmp_lg_u32 s3, 7
    s_cbranch_scc1 MB_126
    s_mov_b64 exec, 0xff
    global_store_dword v168, v38, s[40:41]
    s_mov_b64 exec, -1
MB_126:
OJ_125:
    v_mov_b32 v16, v162
    v_mov_b32 v19, v165
    v_mov_b32 v60, v166
    v_mov_b32 v61, v167
    s_setprio 0
    v_mov_b32 v254, 163784
    v_mov_b32 v255, 1
    s_mov_b64 exec, 1
    ds_add_u32 v254, v255
    s_mov_b64 exec, -1
    ds_read_b64_tr_b16 v[64:65], v16 offset:0
    ds_read_b64_tr_b16 v[66:67], v16 offset:1280
    ds_read_b64_tr_b16 v[68:69], v16 offset:32
    ds_read_b64_tr_b16 v[70:71], v16 offset:1312
    ds_read_b64_tr_b16 v[72:73], v16 offset:64
    ds_read_b64_tr_b16 v[74:75], v16 offset:1344
    ds_read_b64_tr_b16 v[76:77], v16 offset:96
    ds_read_b64_tr_b16 v[78:79], v16 offset:1376
    ds_read_b64_tr_b16 v[80:81], v16 offset:128
    ds_read_b64_tr_b16 v[82:83], v16 offset:1408
    s_waitcnt lgkmcnt(4)
    ds_read_b64_tr_b16 v[84:85], v16 offset:5760
    ds_read_b64_tr_b16 v[86:87], v16 offset:7040
    ds_read_b64_tr_b16 v[88:89], v16 offset:5792
    ds_read_b64_tr_b16 v[90:91], v16 offset:7072
    ds_read_b64_tr_b16 v[92:93], v16 offset:5824
    ds_read_b64_tr_b16 v[94:95], v16 offset:7104
    ds_read_b64_tr_b16 v[96:97], v16 offset:5856
    ds_read_b64_tr_b16 v[98:99], v16 offset:7136
    ds_read_b64_tr_b16 v[100:101], v16 offset:5888
    ds_read_b64_tr_b16 v[102:103], v16 offset:7168
    s_waitcnt lgkmcnt(4)
    ds_read_b64_tr_b16 v[104:105], v16 offset:11520
    ds_read_b64_tr_b16 v[106:107], v16 offset:12800
    ds_read_b64_tr_b16 v[108:109], v16 offset:11552
    ds_read_b64_tr_b16 v[110:111], v16 offset:12832
    ds_read_b64_tr_b16 v[112:113], v16 offset:11584
    ds_read_b64_tr_b16 v[114:115], v16 offset:12864
    ds_read_b64_tr_b16 v[116:117], v16 offset:11616
    ds_read_b64_tr_b16 v[118:119], v16 offset:12896
    ds_read_b64_tr_b16 v[120:121], v16 offset:11648
    ds_read_b64_tr_b16 v[122:123], v16 offset:12928
    s_waitcnt lgkmcnt(4)
    ds_read_b64_tr_b16 v[124:125], v16 offset:17280
    ds_read_b64_tr_b16 v[126:127], v16 offset:18560
    ds_read_b64_tr_b16 v[128:129], v16 offset:17312
    ds_read_b64_tr_b16 v[130:131], v16 offset:18592
    ds_read_b64_tr_b16 v[132:133], v16 offset:17344
    ds_read_b64_tr_b16 v[134:135], v16 offset:18624
    ds_read_b64_tr_b16 v[136:137], v16 offset:17376
    ds_read_b64_tr_b16 v[138:139], v16 offset:18656
    ds_read_b64_tr_b16 v[140:141], v16 offset:17408
    ds_read_b64_tr_b16 v[142:143], v16 offset:18688
    s_waitcnt lgkmcnt(4)
    s_waitcnt vmcnt(0)
    s_barrier
    buffer_load_dwordx4 v[24:27], v60, s[44:47], s56 offen sc1
    buffer_load_dwordx4 v[28:31], v60, s[44:47], s57 offen sc1
    buffer_load_dwordx4 v[32:35], v60, s[44:47], s58 offen sc1
    buffer_load_dwordx4 v[36:39], v60, s[44:47], s59 offen sc1
    ds_read_b64_tr_b16 v[144:145], v16 offset:23040
    ds_read_b64_tr_b16 v[146:147], v16 offset:24320
    ds_read_b64_tr_b16 v[148:149], v16 offset:23072
    ds_read_b64_tr_b16 v[150:151], v16 offset:24352
    ds_read_b64_tr_b16 v[152:153], v16 offset:23104
    ds_read_b64_tr_b16 v[154:155], v16 offset:24384
    ds_read_b64_tr_b16 v[156:157], v16 offset:23136
    ds_read_b64_tr_b16 v[158:159], v16 offset:24416
    ds_read_b64_tr_b16 v[160:161], v16 offset:23168
    ds_read_b64_tr_b16 v[162:163], v16 offset:24448
    s_waitcnt lgkmcnt(4)
    ds_read_b64_tr_b16 v[164:165], v16 offset:28800
    ds_read_b64_tr_b16 v[166:167], v16 offset:30080
    ds_read_b64_tr_b16 v[168:169], v16 offset:28832
    ds_read_b64_tr_b16 v[170:171], v16 offset:30112
    ds_read_b64_tr_b16 v[172:173], v16 offset:28864
    ds_read_b64_tr_b16 v[174:175], v16 offset:30144
    ds_read_b64_tr_b16 v[176:177], v16 offset:28896
    ds_read_b64_tr_b16 v[178:179], v16 offset:30176
    ds_read_b64_tr_b16 v[180:181], v16 offset:28928
    ds_read_b64_tr_b16 v[182:183], v16 offset:30208
    s_waitcnt lgkmcnt(4)
    ds_read_b64_tr_b16 v[184:185], v16 offset:34560
    ds_read_b64_tr_b16 v[186:187], v16 offset:35840
    ds_read_b64_tr_b16 v[188:189], v16 offset:34592
    ds_read_b64_tr_b16 v[190:191], v16 offset:35872
    ds_read_b64_tr_b16 v[192:193], v16 offset:34624
    ds_read_b64_tr_b16 v[194:195], v16 offset:35904
    ds_read_b64_tr_b16 v[196:197], v16 offset:34656
    ds_read_b64_tr_b16 v[198:199], v16 offset:35936
    ds_read_b64_tr_b16 v[200:201], v16 offset:34688
    ds_read_b64_tr_b16 v[202:203], v16 offset:35968
    s_waitcnt lgkmcnt(4)
    ds_read_b64_tr_b16 v[204:205], v16 offset:40320
    ds_read_b64_tr_b16 v[206:207], v16 offset:41600
    ds_read_b64_tr_b16 v[208:209], v16 offset:40352
    ds_read_b64_tr_b16 v[210:211], v16 offset:41632
    ds_read_b64_tr_b16 v[212:213], v16 offset:40384
    ds_read_b64_tr_b16 v[214:215], v16 offset:41664
    ds_read_b64_tr_b16 v[216:217], v16 offset:40416
    ds_read_b64_tr_b16 v[218:219], v16 offset:41696
    ds_read_b64_tr_b16 v[220:221], v16 offset:40448
    ds_read_b64_tr_b16 v[222:223], v16 offset:41728
    s_waitcnt lgkmcnt(4)
    ds_read_b64_tr_b16 v[224:225], v19 offset:0
    ds_read_b64_tr_b16 v[226:227], v19 offset:5760
    ds_read_b64_tr_b16 v[228:229], v19 offset:32
    ds_read_b64_tr_b16 v[230:231], v19 offset:5792
    ds_read_b64_tr_b16 v[232:233], v19 offset:64
    ds_read_b64_tr_b16 v[234:235], v19 offset:5824
    ds_read_b64_tr_b16 v[236:237], v19 offset:96
    ds_read_b64_tr_b16 v[238:239], v19 offset:5856
    ds_read_b64_tr_b16 v[240:241], v19 offset:128
    ds_read_b64_tr_b16 v[242:243], v19 offset:5888
    s_waitcnt lgkmcnt(4)
K_OP:
    s_mov_b32 s91, 400000
    s_waitcnt lgkmcnt(0)
    s_waitcnt vmcnt(3)
    v_max3_u32 v62, v24, v25, v26
    v_max_u32 v62, v62, v27
    v_cmp_eq_u32 vcc, -1, v62
    s_cbranch_vccnz OP_R0
OP_G0:
    v_mfma_f32_16x16x32_bf16 v[4:7], v[64:67], v[24:27], 0
    buffer_load_dwordx4 v[40:43], v60, s[44:47], s82 offen sc1
    v_mfma_f32_16x16x32_bf16 v[8:11], v[68:71], v[24:27], 0
    s_waitcnt vmcnt(3)
    v_max3_u32 v62, v28, v29, v30
    v_mfma_f32_16x16x32_bf16 v[12:15], v[72:75], v[24:27], 0
    v_max_u32 v62, v62, v31
    v_mfma_f32_16x16x32_bf16 v[16:19], v[76:79], v[24:27], 0
    v_cmp_eq_u32 vcc, -1, v62
    v_mfma_f32_16x16x32_bf16 v[20:23], v[80:83], v[24:27], 0
    s_cbranch_vccnz OP_R1
OP_G1:
    v_mfma_f32_16x16x32_bf16 v[4:7], v[84:87], v[28:31], v[4:7]
    buffer_load_dwordx4 v[44:47], v60, s[44:47], s83 offen sc1
    v_mfma_f32_16x16x32_bf16 v[8:11], v[88:91], v[28:31], v[8:11]
    s_waitcnt vmcnt(3)
    v_max3_u32 v62, v32, v33, v34
    v_mfma_f32_16x16x32_bf16 v[12:15], v[92:95], v[28:31], v[12:15]
    v_max_u32 v62, v62, v35
    v_mfma_f32_16x16x32_bf16 v[16:19], v[96:99], v[28:31], v[16:19]
    v_cmp_eq_u32 vcc, -1, v62
    v_mfma_f32_16x16x32_bf16 v[20:23], v[100:103], v[28:31], v[20:23]
    s_cbranch_vccnz OP_R2
OP_G2:
    v_mfma_f32_16x16x32_bf16 v[4:7], v[104:107], v[32:35], v[4:7]
    buffer_load_dwordx4 v[48:51], v60, s[44:47], s84 offen sc1
    v_mfma_f32_16x16x32_bf16 v[8:11], v[108:111], v[32:35], v[8:11]
    s_waitcnt vmcnt(3)
    v_max3_u32 v62, v36, v37, v38
    v_mfma_f32_16x16x32_bf16 v[12:15], v[112:115], v[32:35], v[12:15]
    v_max_u32 v62, v62, v39
    v_mfma_f32_16x16x32_bf16 v[16:19], v[116:119], v[32:35], v[16:19]
    v_cmp_eq_u32 vcc, -1, v62
    v_mfma_f32_16x16x32_bf16 v[20:23], v[120:123], v[32:35], v[20:23]
    s_cbranch_vccnz OP_R3
OP_G3:
    v_mfma_f32_16x16x32_bf16 v[4:7], v[124:127], v[36:39], v[4:7]
    buffer_load_dwordx4 v[52:55], v60, s[44:47], s85 offen sc1
    v_mfma_f32_16x16x32_bf16 v[8:11], v[128:131], v[36:39], v[8:11]
    s_waitcnt vmcnt(3)
    v_max3_u32 v62, v40, v41, v42
    v_mfma_f32_16x16x32_bf16 v[12:15], v[132:135], v[36:39], v[12:15]
    v_max_u32 v62, v62, v43
    v_mfma_f32_16x16x32_bf16 v[16:19], v[136:139], v[36:39], v[16:19]
    v_cmp_eq_u32 vcc, -1, v62
    v_mfma_f32_16x16x32_bf16 v[20:23], v[140:143], v[36:39], v[20:23]
    s_cbranch_vccnz OP_R4
OP_G4:
    v_mfma_f32_16x16x32_bf16 v[4:7], v[144:147], v[40:43], v[4:7]
    buffer_load_dword v56, v61, s[44:47], s81 offen offset:0 sc1
    buffer_load_dword v57, v61, s[44:47], s81 offen offset:256 sc1
    buffer_load_dword v58, v61, s[44:47], s81 offen offset:512 sc1
    buffer_load_dword v59, v61, s[44:47], s81 offen offset:768 sc1
    v_mfma_f32_16x16x32_bf16 v[8:11], v[148:151], v[40:43], v[8:11]
    s_waitcnt vmcnt(6)
    v_max3_u32 v62, v44, v45, v46
    v_mfma_f32_16x16x32_bf16 v[12:15], v[152:155], v[40:43], v[12:15]
    v_max_u32 v62, v62, v47
    v_mfma_f32_16x16x32_bf16 v[16:19], v[156:159], v[40:43], v[16:19]
    v_cmp_eq_u32 vcc, -1, v62
    v_mfma_f32_16x16x32_bf16 v[20:23], v[160:163], v[40:43], v[20:23]
    s_cbranch_vccnz OP_R5
OP_G5:
    v_mfma_f32_16x16x32_bf16 v[4:7], v[164:167], v[44:47], v[4:7]
    v_mfma_f32_16x16x32_bf16 v[8:11], v[168:171], v[44:47], v[8:11]
    s_waitcnt vmcnt(5)
    v_max3_u32 v62, v48, v49, v50
    v_mfma_f32_16x16x32_bf16 v[12:15], v[172:175], v[44:47], v[12:15]
    v_max_u32 v62, v62, v51
    v_mfma_f32_16x16x32_bf16 v[16:19], v[176:179], v[44:47], v[16:19]
    v_cmp_eq_u32 vcc, -1, v62
    v_mfma_f32_16x16x32_bf16 v[20:23], v[180:183], v[44:47], v[20:23]
    s_cbranch_vccnz OP_R6
OP_G6:
    v_mfma_f32_16x16x32_bf16 v[4:7], v[184:187], v[48:51], v[4:7]
    v_mfma_f32_16x16x32_bf16 v[8:11], v[188:191], v[48:51], v[8:11]
    s_waitcnt vmcnt(4)
    v_max3_u32 v62, v52, v53, v54
    v_mfma_f32_16x16x32_bf16 v[12:15], v[192:195], v[48:51], v[12:15]
    v_max_u32 v62, v62, v55
    v_mfma_f32_16x16x32_bf16 v[16:19], v[196:199], v[48:51], v[16:19]
    v_cmp_eq_u32 vcc, -1, v62
    v_mfma_f32_16x16x32_bf16 v[20:23], v[200:203], v[48:51], v[20:23]
    s_cbranch_vccnz OP_R7
OP_G7:
    v_mfma_f32_16x16x32_bf16 v[4:7], v[204:207], v[52:55], v[4:7]
    v_mfma_f32_16x16x32_bf16 v[8:11], v[208:211], v[52:55], v[8:11]
    s_waitcnt vmcnt(0)
    v_max3_u32 v62, v56, v57, v58
    v_mfma_f32_16x16x32_bf16 v[12:15], v[212:215], v[52:55], v[12:15]
    v_max_u32 v62, v62, v59
    v_mfma_f32_16x16x32_bf16 v[16:19], v[216:219], v[52:55], v[16:19]
    v_cmp_eq_u32 vcc, -1, v62
    v_mfma_f32_16x16x32_bf16 v[20:23], v[220:223], v[52:55], v[20:23]
    s_cbranch_vccnz OP_R8
OP_G8:
    v_mfma_f32_16x16x32_bf16 v[4:7], v[224:227], v[56:59], v[4:7]
    v_mfma_f32_16x16x32_bf16 v[8:11], v[228:231], v[56:59], v[8:11]
    v_mfma_f32_16x16x32_bf16 v[12:15], v[232:235], v[56:59], v[12:15]
    v_mfma_f32_16x16x32_bf16 v[16:19], v[236:239], v[56:59], v[16:19]
    v_mfma_f32_16x16x32_bf16 v[20:23], v[240:243], v[56:59], v[20:23]
    s_nop 3
    ds_write_b128 v244, v[4:7] offset:0
    ds_write_b128 v244, v[8:11] offset:64
    ds_write_b128 v244, v[12:15] offset:128
    ds_write_b128 v244, v[16:19] offset:192
    s_mov_b32 exec_hi, 0
    ds_write_b128 v244, v[20:23] offset:256
    s_mov_b32 exec_hi, -1
    s_waitcnt lgkmcnt(0)
    s_barrier
    ds_read_b128 v[24:27], v245 offset:0
    ds_read_b128 v[32:35], v245 offset:19456
    ds_read_b128 v[28:31], v245 offset:16
    ds_read_b128 v[36:39], v245 offset:19472
    s_mov_b64 exec, 0x1ff
    ds_read_b128 v[40:43], v245 offset:2128
    ds_read_b128 v[48:51], v245 offset:21584
    ds_read_b128 v[44:47], v245 offset:2144
    ds_read_b128 v[52:55], v245 offset:21600
    s_mov_b64 exec, -1
    s_waitcnt lgkmcnt(4)
    v_add_f32 v24, v24, v32
    v_add_f32 v25, v25, v33
    v_add_f32 v26, v26, v34
    v_add_f32 v27, v27, v35
    v_add_f32 v28, v28, v36
    v_add_f32 v29, v29, v37
    v_add_f32 v30, v30, v38
    v_add_f32 v31, v31, v39
    v_cvt_pk_bf16_f32 v4, v24, v25
    v_cvt_pk_bf16_f32 v5, v26, v27
    v_cvt_pk_bf16_f32 v6, v28, v29
    v_cvt_pk_bf16_f32 v7, v30, v31
    buffer_store_dwordx4 v[4:7], v246, s[48:51], s79 offen
    s_waitcnt lgkmcnt(0)
    s_mov_b64 exec, 0x1ff
    v_add_f32 v40, v40, v48
    v_add_f32 v41, v41, v49
    v_add_f32 v42, v42, v50
    v_add_f32 v43, v43, v51
    v_add_f32 v44, v44, v52
    v_add_f32 v45, v45, v53
    v_add_f32 v46, v46, v54
    v_add_f32 v47, v47, v55
    v_cvt_pk_bf16_f32 v8, v40, v41
    v_cvt_pk_bf16_f32 v9, v42, v43
    v_cvt_pk_bf16_f32 v10, v44, v45
    v_cvt_pk_bf16_f32 v11, v46, v47
    buffer_store_dwordx4 v[8:11], v246, s[48:51], s80 offen
K_END:
    s_endpgm
K_HELP:
    s_setprio 3
    s_lshr_b32 s43, s5, 1
    s_lshl_b32 s43, s43, 2
    s_and_b32 s82, s7, 3
    s_add_u32 s43, s43, s82
    s_mul_i32 s80, s6, 72
    s_and_b32 s82, s43, 7
    s_add_u32 s82, s82, s80
    s_add_u32 s82, s82, 64
    s_lshl_b32 s81, s7, 1
    s_add_u32 s80, s80, s81
    s_add_u32 s81, s80, 1
    s_sub_u32 s79, 4, s42
    s_cmp_lg_u32 s3, 3
    s_cbranch_scc1 K_H2
    s_mov_b32 s48, s10
    s_mov_b32 s49, s11
    s_mov_b32 s50, 663552
    s_mov_b32 s51, 0x20000
    v_add_u32 v2, 0, v0
    v_mul_u32_u24 v3, 7282, v2
    v_lshrrev_b32 v3, 16, v3
    v_mul_u32_u24 v3, 1008, v3
    v_lshl_add_u32 v16, v2, 4, v3
    v_add_u32 v2, 64, v0
    v_mul_u32_u24 v3, 7282, v2
    v_lshrrev_b32 v3, 16, v3
    v_mul_u32_u24 v3, 1008, v3
    v_lshl_add_u32 v17, v2, 4, v3
    v_subrev_u32 v17, 1024, v17
    v_add_u32 v2, 128, v0
    v_mul_u32_u24 v3, 7282, v2
    v_lshrrev_b32 v3, 16, v3
    v_mul_u32_u24 v3, 1008, v3
    v_lshl_add_u32 v18, v2, 4, v3
    v_subrev_u32 v18, 2048, v18
    v_add_u32 v2, 192, v0
    v_mul_u32_u24 v3, 7282, v2
    v_lshrrev_b32 v3, 16, v3
    v_mul_u32_u24 v3, 1008, v3
    v_lshl_add_u32 v19, v2, 4, v3
    v_subrev_u32 v19, 3072, v19
    v_add_u32 v2, 256, v0
    v_mul_u32_u24 v3, 7282, v2
    v_lshrrev_b32 v3, 16, v3
    v_mul_u32_u24 v3, 1008, v3
    v_lshl_add_u32 v20, v2, 4, v3
    v_add_u32 v2, 320, v0
    v_mul_u32_u24 v3, 7282, v2
    v_lshrrev_b32 v3, 16, v3
    v_mul_u32_u24 v3, 1008, v3
    v_lshl_add_u32 v21, v2, 4, v3
    v_subrev_u32 v21, 1024, v21
    v_add_u32 v2, 384, v0
    v_mul_u32_u24 v3, 7282, v2
    v_lshrrev_b32 v3, 16, v3
    v_mul_u32_u24 v3, 1008, v3
    v_lshl_add_u32 v22, v2, 4, v3
    v_subrev_u32 v22, 2048, v22
    v_add_u32 v2, 448, v0
    v_mul_u32_u24 v3, 7282, v2
    v_lshrrev_b32 v3, 16, v3
    v_mul_u32_u24 v3, 1008, v3
    v_lshl_add_u32 v23, v2, 4, v3
    v_subrev_u32 v23, 3072, v23
    v_add_u32 v2, 512, v0
    v_mul_u32_u24 v3, 7282, v2
    v_lshrrev_b32 v3, 16, v3
    v_mul_u32_u24 v3, 1008, v3
    v_lshl_add_u32 v24, v2, 4, v3
    s_mul_i32 s66, s5, 144
    s_mov_b32 s70, 0
    s_mov_b32 s67, 73728
    v_mov_b32 v8, 163812
    s_add_u32 s62, s4, 64
    s_lshl_b32 s90, s62, 7
    s_add_u32 s90, s90, 196608
    v_and_b32 v6, 0, v0
    v_lshl_add_u32 v6, v6, 7, s90
    s_add_u32 s52, s40, 0
    s_addc_u32 s53, s41, 0
    s_mov_b32 s54, 151552
    s_mov_b32 s55, 0x20000
    s_and_b32 s76, s3, 3
    s_mul_i32 s76, s76, 4736
    s_add_u32 s78, s76, 56832
    s_add_u32 s76, s76, 37888
    s_mov_b32 s77, s76
    v_lshlrev_b32 v26, 4, v0
    v_mov_b32 v254, 163780
    s_mov_b32 s91, 3200000
LW_177:
    ds_read_b32 v255, v254
    s_waitcnt lgkmcnt(0)
    v_readfirstlane_b32 s90, v255
    s_sub_u32 s91, s91, 1
    s_cbranch_scc1 LWD_178
    s_cmp_ge_u32 s90, 4
    s_cbranch_scc1 LWD_178
    s_sleep 1
    s_branch LW_177
LWD_178:
    v_mov_b32 v4, 0
    s_mov_b64 exec, 1
    global_load_dword v5, v4, s[38:39] sc1
    s_mov_b64 exec, -1
LDW_179:
    s_mov_b32 m0, s67
    s_add_u32 s67, s67, 9216
    buffer_load_dwordx4 v16, s[48:51], s66 offen offset:0 lds
    buffer_load_dwordx4 v17, s[48:51], s66 offen offset:1024 lds
    buffer_load_dwordx4 v18, s[48:51], s66 offen offset:2048 lds
    buffer_load_dwordx4 v19, s[48:51], s66 offen offset:3072 lds
    s_add_u32 m0, m0, 4096
    s_add_u32 s70, s70, 1
    buffer_load_dwordx4 v20, s[48:51], s66 offen offset:0 lds
    buffer_load_dwordx4 v21, s[48:51], s66 offen offset:1024 lds
    buffer_load_dwordx4 v22, s[48:51], s66 offen offset:2048 lds
    buffer_load_dwordx4 v23, s[48:51], s66 offen offset:3072 lds
    s_add_u32 m0, m0, 4096
    s_nop 0
    buffer_load_dwordx4 v24, s[48:51], s66 offen offset:0 lds
    s_add_u32 s66, s66, 73728
    s_cmp_eq_u32 s67, 110592
    s_cselect_b32 s67, 73728, s67
    s_cmp_lt_u32 s70, 2
    s_cbranch_scc1 LDW_179
    s_cmp_eq_u32 s70, 9
    s_cbranch_scc1 LDF_182
    s_sub_u32 s73, s70, 1
    s_waitcnt vmcnt(9)
    v_mov_b32 v10, s73
    s_mov_b64 exec, 1
    ds_write_b32 v8, v10
    s_mov_b64 exec, -1
    s_sub_u32 s72, s70, 3
    s_cmp_lt_u32 s70, 4
    s_cbranch_scc1 LDW_179
    v_mov_b32 v251, 163824
    s_mov_b32 s91, 3200000
L4_183:
    ds_read_b128 v[252:255], v251
    s_waitcnt lgkmcnt(0)
    v_min3_u32 v252, v252, v253, v254
    v_min_u32 v252, v252, v255
    s_sub_u32 s91, s91, 1
    v_readfirstlane_b32 s90, v252
    s_cbranch_scc1 L4D_184
    s_cmp_ge_u32 s90, s72
    s_cbranch_scc1 L4D_184
    s_branch L4_183
L4D_184:
    s_branch LDW_179
LDF_182:
    v_readfirstlane_b32 s60, v5
    s_cmp_lg_u32 s60, 0
    s_cbranch_scc1 LDK_185
    v_mov_b32 v254, 0
    s_mov_b32 s91, 400000
    s_mov_b64 exec, 1
RW_186:
    global_load_dword v255, v254, s[38:39] sc1
    s_waitcnt vmcnt(0)
    v_cmp_eq_u32 vcc, 0, v255
    s_cbranch_vccz RWD_187
    s_sub_u32 s91, s91, 1
    s_cbranch_scc1 RWD_187
    s_sleep 8
    s_branch RW_186
RWD_187:
    s_mov_b64 exec, -1
LDK_185:
    s_mov_b64 exec, 1
    global_load_dword v7, v6, s[40:41] sc1
    s_mov_b64 exec, -1
    s_waitcnt vmcnt(10)
    v_mov_b32 v10, 8
    s_mov_b64 exec, 1
    ds_write_b32 v8, v10
    s_mov_b64 exec, -1
    s_waitcnt vmcnt(1)
    v_mov_b32 v10, 9
    s_mov_b64 exec, 1
    ds_write_b32 v8, v10
    s_mov_b64 exec, -1
    s_mov_b32 s91, 400000
    s_mov_b64 exec, 1
GP_188:
    s_waitcnt vmcnt(0)
    v_cmp_ne_u32 vcc, 8, v7
    s_cbranch_vccz GPD_189
    s_sub_u32 s91, s91, 1
    s_cbranch_scc1 GPD_189
    s_sleep 2
    global_load_dword v7, v6, s[40:41] sc1
    s_branch GP_188
GPD_189:
    s_mov_b64 exec, -1
    s_mov_b32 m0, 0
    s_mov_b32 s60, 0
    buffer_load_dwordx4 v26, s[52:55], s60 offen offset:0 sc1 lds
    buffer_load_dwordx4 v26, s[52:55], s60 offen offset:1024 sc1 lds
    buffer_load_dwordx4 v26, s[52:55], s60 offen offset:2048 sc1 lds
    buffer_load_dwordx4 v26, s[52:55], s60 offen offset:3072 sc1 lds
    s_mov_b32 m0, 4096
    s_mov_b32 s60, 4096
    buffer_load_dwordx4 v26, s[52:55], s60 offen offset:0 sc1 lds
    buffer_load_dwordx4 v26, s[52:55], s60 offen offset:1024 sc1 lds
    buffer_load_dwordx4 v26, s[52:55], s60 offen offset:2048 sc1 lds
    buffer_load_dwordx4 v26, s[52:55], s60 offen offset:3072 sc1 lds
    s_mov_b32 m0, 8192
    s_mov_b32 s60, 8192
    buffer_load_dwordx4 v26, s[52:55], s60 offen offset:0 sc1 lds
    buffer_load_dwordx4 v26, s[52:55], s60 offen offset:1024 sc1 lds
    buffer_load_dwordx4 v26, s[52:55], s60 offen offset:2048 sc1 lds
    buffer_load_dwordx4 v26, s[52:55], s60 offen offset:3072 sc1 lds
    s_mov_b32 m0, 12288
    s_mov_b32 s60, 12288
    buffer_load_dwordx4 v26, s[52:55], s60 offen offset:0 sc1 lds
    buffer_load_dwordx4 v26, s[52:55], s60 offen offset:1024 sc1 lds
    buffer_load_dwordx4 v26, s[52:55], s60 offen offset:2048 sc1 lds
    buffer_load_dwordx4 v26, s[52:55], s60 offen offset:3072 sc1 lds
    s_mov_b32 m0, 16384
    s_mov_b32 s60, 16384
    buffer_load_dwordx4 v26, s[52:55], s60 offen offset:0 sc1 lds
    buffer_load_dwordx4 v26, s[52:55], s60 offen offset:1024 sc1 lds
    buffer_load_dwordx4 v26, s[52:55], s60 offen offset:2048 sc1 lds
    buffer_load_dwordx4 v26, s[52:55], s60 offen offset:3072 sc1 lds
    s_mov_b32 m0, 20480
    s_mov_b32 s60, 20480
    buffer_load_dwordx4 v26, s[52:55], s60 offen offset:0 sc1 lds
    buffer_load_dwordx4 v26, s[52:55], s60 offen offset:1024 sc1 lds
    buffer_load_dwordx4 v26, s[52:55], s60 offen offset:2048 sc1 lds
    buffer_load_dwordx4 v26, s[52:55], s60 offen offset:3072 sc1 lds
    s_mov_b32 m0, 24576
    s_mov_b32 s60, 24576
    buffer_load_dwordx4 v26, s[52:55], s60 offen offset:0 sc1 lds
    buffer_load_dwordx4 v26, s[52:55], s60 offen offset:1024 sc1 lds
    buffer_load_dwordx4 v26, s[52:55], s60 offen offset:2048 sc1 lds
    buffer_load_dwordx4 v26, s[52:55], s60 offen offset:3072 sc1 lds
    s_mov_b32 m0, 28672
    s_mov_b32 s60, 28672
    buffer_load_dwordx4 v26, s[52:55], s60 offen offset:0 sc1 lds
    buffer_load_dwordx4 v26, s[52:55], s60 offen offset:1024 sc1 lds
    buffer_load_dwordx4 v26, s[52:55], s60 offen offset:2048 sc1 lds
    buffer_load_dwordx4 v26, s[52:55], s60 offen offset:3072 sc1 lds
    s_mov_b32 m0, 32768
    s_mov_b32 s60, 32768
    buffer_load_dwordx4 v26, s[52:55], s60 offen offset:0 sc1 lds
    buffer_load_dwordx4 v26, s[52:55], s60 offen offset:1024 sc1 lds
    buffer_load_dwordx4 v26, s[52:55], s60 offen offset:2048 sc1 lds
    buffer_load_dwordx4 v26, s[52:55], s60 offen offset:3072 sc1 lds
    s_mov_b32 m0, 36864
    s_mov_b32 s60, 36864
    buffer_load_dwordx4 v26, s[52:55], s60 offen offset:0 sc1 lds
    v_mov_b32 v251, 163824
    s_mov_b32 s91, 3200000
L4_190:
    ds_read_b128 v[252:255], v251
    s_waitcnt lgkmcnt(0)
    v_min3_u32 v252, v252, v253, v254
    v_min_u32 v252, v252, v255
    s_sub_u32 s91, s91, 1
    v_readfirstlane_b32 s90, v252
    s_cbranch_scc1 L4D_191
    s_cmp_ge_u32 s90, 6
    s_cbranch_scc1 L4D_191
    s_branch L4_190
L4D_191:
    s_mov_b32 s44, s18
    s_mov_b32 s45, s19
    s_mov_b32 s46, 2359296
    s_mov_b32 s47, 0x20000
    v_mul_u32_u24 v2, 7282, v0
    v_lshrrev_b32 v2, 16, v2
    v_mul_u32_u24 v4, 9, v2
    v_sub_u32 v3, v0, v4
    v_mul_u32_u24 v2, 1152, v2
    v_lshl_add_u32 v2, v3, 4, v2
    s_mul_i32 s60, s7, 73728
    s_mul_i32 s61, s6, 144
    s_add_u32 s60, s60, s61
    s_mov_b32 m0, 82944
    s_nop 0
    buffer_load_dwordx4 v2, s[44:47], s60 offen lds
    s_add_u32 s60, s60, 8064
    s_add_u32 m0, m0, 1008
    s_nop 0
    buffer_load_dwordx4 v2, s[44:47], s60 offen lds
    s_add_u32 s60, s60, 8064
    s_add_u32 m0, m0, 1008
    s_nop 0
    buffer_load_dwordx4 v2, s[44:47], s60 offen lds
    s_add_u32 s60, s60, 8064
    s_add_u32 m0, m0, 1008
    s_nop 0
    buffer_load_dwordx4 v2, s[44:47], s60 offen lds
    s_add_u32 s60, s60, 8064
    s_add_u32 m0, m0, 1008
    s_nop 0
    buffer_load_dwordx4 v2, s[44:47], s60 offen lds
    s_add_u32 s60, s60, 8064
    s_add_u32 m0, m0, 1008
    s_nop 0
    buffer_load_dwordx4 v2, s[44:47], s60 offen lds
    s_add_u32 s60, s60, 8064
    s_add_u32 m0, m0, 1008
    s_nop 0
    buffer_load_dwordx4 v2, s[44:47], s60 offen lds
    s_add_u32 s60, s60, 8064
    s_add_u32 m0, m0, 1008
    s_nop 0
    buffer_load_dwordx4 v2, s[44:47], s60 offen lds
    s_add_u32 s60, s60, 8064
    s_add_u32 m0, m0, 1008
    s_nop 0
    buffer_load_dwordx4 v2, s[44:47], s60 offen lds
    s_add_u32 s60, s60, 8064
    s_add_u32 m0, m0, 1008
    s_mov_b64 exec, 0x1ff
    buffer_load_dwordx4 v2, s[44:47], s60 offen lds
    s_mov_b64 exec, -1
    s_waitcnt vmcnt(28)
    v_mov_b32 v254, 163788
    v_mov_b32 v255, 1
    s_mov_b64 exec, 1
    ds_add_u32 v254, v255
    s_mov_b64 exec, -1
    s_waitcnt vmcnt(10)
    v_mov_b32 v254, 163788
    v_mov_b32 v255, 1
    s_mov_b64 exec, 1
    ds_add_u32 v254, v255
    s_mov_b64 exec, -1
    s_add_u32 s48, s40, 262144
    s_addc_u32 s49, s41, 0
    s_mov_b32 s50, 2359296
    s_mov_b32 s51, 0x20000
    v_bfe_u32 v3, v0, 4, 1
    v_and_b32 v4, 3, v0
    v_lshl_add_u32 v3, v3, 2, v4
    v_bfe_u32 v4, v0, 2, 2
    v_lshl_add_u32 v3, v3, 3, v4
    v_sub_u32 v3, 59, v3
    v_mul_u32_u24 v3, 144, v3
    v_lshrrev_b32 v4, 5, v0
    v_lshl_add_u32 v3, v4, 3, v3
    v_add_u32 v3, 82944, v3
    v_and_b32 v5, 3, v0
    v_bfe_u32 v6, v0, 2, 3
    v_lshlrev_b32 v7, 1, v5
    v_xor_b32 v6, v6, v7
    v_lshl_add_u32 v5, v4, 2, v5
    v_lshlrev_b32 v5, 7, v5
    v_lshl_add_u32 v5, v6, 4, v5
    v_add_u32 v5, 82944, v5
    v_lshlrev_b32 v6, 4, v0
    v_add_u32 v6, 82944, v6
    v_bfe_u32 v4, v0, 3, 2
    v_lshlrev_b32 v4, 1, v4
    v_xor_b32 v4, v4, v0
    v_and_b32 v4, 7, v4
    v_lshrrev_b32 v7, 3, v0
    v_lshlrev_b32 v7, 12, v7
    v_lshl_add_u32 v7, v4, 4, v7
    s_mul_i32 s60, s6, 294912
    s_sub_u32 s61, 31, s7
    s_lshl_b32 s61, s61, 7
    s_add_u32 s60, s60, s61
    s_waitcnt vmcnt(0)
    ds_read_b64_tr_b16 v[8:9], v3 offset:576
    ds_read_b64_tr_b16 v[10:11], v3 offset:0
    ds_read_b64_tr_b16 v[12:13], v3 offset:592
    ds_read_b64_tr_b16 v[14:15], v3 offset:16
    ds_read_b64_tr_b16 v[16:17], v3 offset:608
    ds_read_b64_tr_b16 v[18:19], v3 offset:32
    ds_read_b64_tr_b16 v[20:21], v3 offset:624
    ds_read_b64_tr_b16 v[22:23], v3 offset:48
    ds_read_b64_tr_b16 v[24:25], v3 offset:640
    ds_read_b64_tr_b16 v[26:27], v3 offset:64
    ds_read_b64_tr_b16 v[28:29], v3 offset:656
    ds_read_b64_tr_b16 v[30:31], v3 offset:80
    s_waitcnt lgkmcnt(6)
    ds_read_b64_tr_b16 v[32:33], v3 offset:672
    ds_read_b64_tr_b16 v[34:35], v3 offset:96
    ds_read_b64_tr_b16 v[36:37], v3 offset:688
    ds_read_b64_tr_b16 v[38:39], v3 offset:112
    ds_read_b64_tr_b16 v[40:41], v3 offset:704
    ds_read_b64_tr_b16 v[42:43], v3 offset:128
    s_waitcnt lgkmcnt(0)
    ds_write_b128 v5, v[8:11] offset:0
    ds_read_b128 v[44:47], v6 offset:0
    ds_write_b128 v5, v[12:15] offset:1024
    ds_read_b128 v[48:51], v6 offset:1024
    ds_write_b128 v5, v[16:19] offset:2048
    ds_read_b128 v[52:55], v6 offset:2048
    s_waitcnt lgkmcnt(4)
    buffer_store_dwordx4 v[44:47], v7, s[48:51], s60 offen sc1
    s_add_u32 s60, s60, 32768
    ds_write_b128 v5, v[20:23] offset:3072
    ds_read_b128 v[56:59], v6 offset:3072
    s_waitcnt lgkmcnt(4)
    buffer_store_dwordx4 v[48:51], v7, s[48:51], s60 offen sc1
    s_add_u32 s60, s60, 32768
    ds_write_b128 v5, v[24:27] offset:4096
    ds_read_b128 v[60:63], v6 offset:4096
    s_waitcnt lgkmcnt(4)
    buffer_store_dwordx4 v[52:55], v7, s[48:51], s60 offen sc1
    s_add_u32 s60, s60, 32768
    ds_write_b128 v5, v[28:31] offset:5120
    ds_read_b128 v[64:67], v6 offset:5120
    s_waitcnt lgkmcnt(4)
    buffer_store_dwordx4 v[56:59], v7, s[48:51], s60 offen sc1
    s_add_u32 s60, s60, 32768
    ds_write_b128 v5, v[32:35] offset:6144
    ds_read_b128 v[68:71], v6 offset:6144
    s_waitcnt lgkmcnt(4)
    buffer_store_dwordx4 v[60:63], v7, s[48:51], s60 offen sc1
    s_add_u32 s60, s60, 32768
    ds_write_b128 v5, v[36:39] offset:7168
    ds_read_b128 v[72:75], v6 offset:7168
    s_waitcnt lgkmcnt(4)
    buffer_store_dwordx4 v[64:67], v7, s[48:51], s60 offen sc1
    s_add_u32 s60, s60, 32768
    ds_write_b128 v5, v[40:43] offset:8192
    ds_read_b128 v[76:79], v6 offset:8192
    s_waitcnt lgkmcnt(4)
    buffer_store_dwordx4 v[68:71], v7, s[48:51], s60 offen sc1
    s_add_u32 s60, s60, 32768
    s_waitcnt lgkmcnt(2)
    buffer_store_dwordx4 v[72:75], v7, s[48:51], s60 offen sc1
    s_add_u32 s60, s60, 32768
    s_waitcnt lgkmcnt(0)
    buffer_store_dwordx4 v[76:79], v7, s[48:51], s60 offen sc1
    v_mov_b32 v251, 163824
    s_mov_b32 s91, 3200000
L4_192:
    ds_read_b128 v[252:255], v251
    s_waitcnt lgkmcnt(0)
    v_min3_u32 v252, v252, v253, v254
    v_min_u32 v252, v252, v255
    s_sub_u32 s91, s91, 1
    v_readfirstlane_b32 s90, v252
    s_cbranch_scc1 L4D_193
    s_cmp_ge_u32 s90, 9
    s_cbranch_scc1 L4D_193
    s_sleep 1
    s_branch L4_192
L4D_193:
    s_waitcnt vmcnt(0)
    s_add_u32 s62, s6, 24
    s_lshl_b32 s90, s6, 7
    s_add_u32 s90, s90, 196608
    s_add_u32 s74, s40, s90
    s_addc_u32 s75, s41, 0
    s_mov_b32 s89, 1
    s_atomic_add s89, s[74:75], 0 glc
    s_lshl_b32 s90, s62, 7
    s_add_u32 s90, s90, 196608
    v_lshl_add_u32 v254, v0, 7, s90
    v_mov_b32 v255, 1
    s_waitcnt lgkmcnt(0)
    s_cmp_lg_u32 s89, 31
    s_cbranch_scc1 GA_194
    s_mov_b32 exec_lo, 0x1
    s_mov_b32 exec_hi, 0
    global_atomic_add v254, v255, s[40:41] sc1
    s_mov_b64 exec, -1
GA_194:
    s_lshl_b32 s90, s62, 7
    s_add_u32 s90, s90, 196608
    v_and_b32 v6, 0, v0
    v_lshl_add_u32 v6, v6, 7, s90
    s_mov_b64 exec, 1
    global_load_dword v7, v6, s[40:41] sc1
    s_mov_b64 exec, -1
    v_lshlrev_b32 v2, 4, v0
    v_add_u32 v3, 4, v2
    s_mov_b32 s91, 400000
    s_mov_b64 exec, 1
GP_195:
    s_waitcnt vmcnt(0)
    v_cmp_ne_u32 vcc, 1, v7
    s_cbranch_vccz GPD_196
    s_sub_u32 s91, s91, 1
    s_cbranch_scc1 GPD_196
    s_sleep 4
    global_load_dword v7, v6, s[40:41] sc1
    s_branch GP_195
GPD_196:
    s_mov_b64 exec, -1
    s_mov_b32 s84, 56832
    s_mov_b32 s85, s80
K_UL:
    s_lshl_b32 s60, s85, 12
    s_add_u32 s60, s60, 262144
    s_add_u32 s44, s40, s60
    s_addc_u32 s45, s41, 0
    s_mov_b32 s46, 4096
    s_mov_b32 s47, 0x20000
    s_mov_b32 s60, 4096
    s_add_u32 m0, s84, 0
    s_nop 0
    buffer_load_dwordx4 v2, s[44:47], 0 offen offset:0 sc1 lds
    buffer_load_dwordx4 v2, s[44:47], 0 offen offset:1024 sc1 lds
    buffer_load_dwordx4 v2, s[44:47], 0 offen offset:2048 sc1 lds
    buffer_load_dwordx4 v2, s[44:47], 0 offen offset:3072 sc1 lds
    s_add_u32 m0, s84, 4096
    s_mov_b32 exec_hi, 0
    buffer_load_dwordx4 v2, s[44:47], s60 offen lds
    s_mov_b32 exec_hi, -1
    s_add_u32 m0, s84, 4640
    s_nop 0
    buffer_load_dwordx4 v3, s[44:47], 0 offen offset:0 sc1 lds
    buffer_load_dwordx4 v3, s[44:47], 0 offen offset:1024 sc1 lds
    buffer_load_dwordx4 v3, s[44:47], 0 offen offset:2048 sc1 lds
    buffer_load_dwordx4 v3, s[44:47], 0 offen offset:3072 sc1 lds
    s_add_u32 m0, s84, 8736
    s_mov_b32 exec_hi, 0
    buffer_load_dwordx4 v2, s[44:47], s60 offen lds
    s_mov_b32 exec_hi, -1
    s_add_u32 s84, s84, 9280
    s_cmp_eq_u32 s84, 66112
    s_cselect_b32 s85, s81, s82
    s_cbranch_scc1 K_UL
    s_cmp_eq_u32 s84, 84672
    s_cbranch_scc1 K_UD
    s_cmp_eq_u32 s42, 0
    s_cbranch_scc1 K_UL
K_UD:
    s_waitcnt vmcnt(0)
    v_mov_b32 v254, 163776
    v_mov_b32 v255, 1
    s_mov_b64 exec, 1
    ds_add_u32 v254, v255
    s_mov_b64 exec, -1
    s_mul_i32 s60, s7, 20736
    v_lshl_add_u32 v8, v0, 7, s60
    s_mov_b32 exec_hi, 0x3fffff
    global_load_dword v9, v8, s[16:17]
    v_add_u32 v8, 6912, v8
    global_load_dword v10, v8, s[16:17]
    v_add_u32 v8, 6912, v8
    global_load_dword v11, v8, s[16:17]
    s_mov_b64 exec, -1
    s_branch K_CV
K_H2:
    s_mul_i32 s84, s3, 17408
    s_add_u32 s84, s84, 111488
    s_add_u32 s85, s80, s3
    s_cmp_eq_u32 s3, 2
    s_cselect_b32 s85, s82, s85
    s_cbranch_scc0 K_KG
    s_cmp_eq_u32 s42, 0
    s_cbranch_scc1 K_KG
    s_bfe_u32 s86, s5, 0x10001
    s_lshr_b32 s87, s5, 2
    s_cmp_eq_u32 s86, 0
    s_cselect_b32 s48, s12, s14
    s_cselect_b32 s49, s13, s15
    s_mov_b32 s50, 20736
    s_mov_b32 s51, 0x20000
    v_add_u32 v7, 0, v0
    v_mul_u32_u24 v4, 21846, v7
    v_lshrrev_b32 v4, 16, v4
    v_mul_u32_u24 v13, 12, v4
    v_lshlrev_b32 v7, 4, v7
    v_sub_u32 v4, v7, v13
    v_add_u32 v7, 64, v0
    v_mul_u32_u24 v5, 21846, v7
    v_lshrrev_b32 v5, 16, v5
    v_mul_u32_u24 v13, 12, v5
    v_lshlrev_b32 v7, 4, v7
    v_sub_u32 v5, v7, v13
    v_add_u32 v7, 128, v0
    v_mul_u32_u24 v6, 21846, v7
    v_lshrrev_b32 v6, 16, v6
    v_mul_u32_u24 v13, 12, v6
    v_lshlrev_b32 v7, 4, v7
    v_sub_u32 v6, v7, v13
    s_mov_b32 m0, 146304
    s_mov_b32 s68, 0
    buffer_load_dwordx4 v4, s[48:51], s68 offen lds
    s_add_u32 m0, m0, 1024
    s_nop 0
    buffer_load_dwordx4 v5, s[48:51], s68 offen lds
    s_add_u32 m0, m0, 1024
    s_nop 0
    buffer_load_dwordx4 v6, s[48:51], s68 offen lds
    s_add_u32 m0, m0, 1024
    s_add_u32 s68, s68, 2304
    buffer_load_dwordx4 v4, s[48:51], s68 offen lds
    s_add_u32 m0, m0, 1024
    s_nop 0
    buffer_load_dwordx4 v5, s[48:51], s68 offen lds
    s_add_u32 m0, m0, 1024
    s_nop 0
    buffer_load_dwordx4 v6, s[48:51], s68 offen lds
    s_add_u32 m0, m0, 1024
    s_add_u32 s68, s68, 2304
    buffer_load_dwordx4 v4, s[48:51], s68 offen lds
    s_add_u32 m0, m0, 1024
    s_nop 0
    buffer_load_dwordx4 v5, s[48:51], s68 offen lds
    s_add_u32 m0, m0, 1024
    s_nop 0
    buffer_load_dwordx4 v6, s[48:51], s68 offen lds
    s_add_u32 m0, m0, 1024
    s_add_u32 s68, s68, 2304
    buffer_load_dwordx4 v4, s[48:51], s68 offen lds
    s_add_u32 m0, m0, 1024
    s_nop 0
    buffer_load_dwordx4 v5, s[48:51], s68 offen lds
    s_add_u32 m0, m0, 1024
    s_nop 0
    buffer_load_dwordx4 v6, s[48:51], s68 offen lds
    s_add_u32 m0, m0, 1024
    s_add_u32 s68, s68, 2304
    buffer_load_dwordx4 v4, s[48:51], s68 offen lds
    s_add_u32 m0, m0, 1024
    s_nop 0
    buffer_load_dwordx4 v5, s[48:51], s68 offen lds
    s_add_u32 m0, m0, 1024
    s_nop 0
    buffer_load_dwordx4 v6, s[48:51], s68 offen lds
    s_add_u32 m0, m0, 1024
    s_add_u32 s68, s68, 2304
    buffer_load_dwordx4 v[48:51], v4, s[48:51], s68 offen
    buffer_load_dwordx4 v[52:55], v5, s[48:51], s68 offen
    buffer_load_dwordx4 v[56:59], v6, s[48:51], s68 offen
    s_add_u32 s68, s68, 2304
    buffer_load_dwordx4 v[60:63], v4, s[48:51], s68 offen
    buffer_load_dwordx4 v[64:67], v5, s[48:51], s68 offen
    buffer_load_dwordx4 v[68:71], v6, s[48:51], s68 offen
    s_add_u32 s68, s68, 2304
    buffer_load_dwordx4 v[72:75], v4, s[48:51], s68 offen
    buffer_load_dwordx4 v[76:79], v5, s[48:51], s68 offen
    buffer_load_dwordx4 v[80:83], v6, s[48:51], s68 offen
    s_add_u32 s68, s68, 2304
    buffer_load_dwordx4 v[84:87], v4, s[48:51], s68 offen
    buffer_load_dwordx4 v[88:91], v5, s[48:51], s68 offen
    buffer_load_dwordx4 v[92:95], v6, s[48:51], s68 offen
    v_and_b32 v8, 31, v0
    v_lshrrev_b32 v7, 1, v8
    v_lshlrev_b32 v8, 7, v8
    v_lshrrev_b32 v9, 5, v0
    v_xor_b32 v7, v7, v9
    v_and_b32 v7, 7, v7
    v_lshl_add_u32 v8, v7, 4, v8
    v_add_u32 v8, 0, v8
    v_xor_b32 v9, 32, v8
    v_xor_b32 v10, 64, v8
    v_xor_b32 v11, 0x60, v8
    s_and_b32 s64, s5, 3
    s_lshl_b32 s64, s64, 10
    v_xor_b32 v8, s64, v8
    v_add_u32 v112, 65536, v8
    v_xor_b32 v9, s64, v9
    v_add_u32 v113, 65536, v9
    v_xor_b32 v10, s64, v10
    v_add_u32 v114, 65536, v10
    v_xor_b32 v11, s64, v11
    v_add_u32 v115, 65536, v11
    v_bfe_u32 v12, v0, 2, 2
    v_lshrrev_b32 v7, 5, v0
    v_lshl_add_u32 v12, v7, 3, v12
    v_mul_u32_u24 v12, 48, v12
    v_bfe_u32 v7, v0, 4, 1
    v_lshl_add_u32 v12, v7, 5, v12
    v_and_b32 v7, 3, v0
    v_lshl_add_u32 v12, v7, 3, v12
    v_add_u32 v12, 146304, v12
    v_lshlrev_b32 v14, 4, v0
    v_add_u32 v14, 146304, v14
    v_mov_b32 v16, 0
    v_mov_b32 v17, 0
    v_mov_b32 v18, 0
    v_mov_b32 v19, 0
    v_mov_b32 v20, 0
    v_mov_b32 v21, 0
    v_mov_b32 v22, 0
    v_mov_b32 v23, 0
    v_mov_b32 v24, 0
    v_mov_b32 v25, 0
    v_mov_b32 v26, 0
    v_mov_b32 v27, 0
    v_mov_b32 v28, 0
    v_mov_b32 v29, 0
    v_mov_b32 v30, 0
    v_mov_b32 v31, 0
    s_waitcnt vmcnt(0)
    v_mov_b32 v254, 163816
    s_mov_b32 s91, 3200000
LW_197:
    ds_read_b32 v255, v254
    s_waitcnt lgkmcnt(0)
    v_readfirstlane_b32 s90, v255
    s_sub_u32 s91, s91, 1
    s_cbranch_scc1 LWD_198
    s_cmp_ge_u32 s90, 4
    s_cbranch_scc1 LWD_198
    s_branch LW_197
LWD_198:
    ds_read_b64_tr_b16 v[96:97], v12 offset:0
    ds_read_b64_tr_b16 v[98:99], v12 offset:192
    ds_read_b128 v[32:35], v8 offset:0
    ds_read_b64_tr_b16 v[100:101], v12 offset:768
    ds_read_b64_tr_b16 v[102:103], v12 offset:960
    ds_read_b128 v[36:39], v9 offset:0
    ds_read_b64_tr_b16 v[104:105], v12 offset:1536
    ds_read_b64_tr_b16 v[106:107], v12 offset:1728
    ds_read_b128 v[40:43], v10 offset:0
    ds_read_b64_tr_b16 v[108:109], v12 offset:2304
    ds_read_b64_tr_b16 v[110:111], v12 offset:2496
    ds_read_b128 v[44:47], v11 offset:0
    s_cmp_eq_u32 s86, 0
    s_cbranch_scc0 KVV_199
    s_waitcnt lgkmcnt(9)
    v_mfma_f32_32x32x16_bf16 v[16:31], v[96:99], v[32:35], v[16:31]
    ds_write_b128 v14, v[48:51] offset:0
    ds_read_b64_tr_b16 v[96:97], v12 offset:3072
    ds_read_b64_tr_b16 v[98:99], v12 offset:3264
    ds_read_b128 v[32:35], v8 offset:8192
    s_waitcnt lgkmcnt(9)
    v_mfma_f32_32x32x16_bf16 v[16:31], v[100:103], v[36:39], v[16:31]
    ds_write_b128 v14, v[52:55] offset:1024
    ds_read_b64_tr_b16 v[100:101], v12 offset:3840
    ds_read_b64_tr_b16 v[102:103], v12 offset:4032
    ds_read_b128 v[36:39], v9 offset:8192
    s_waitcnt lgkmcnt(9)
    v_mfma_f32_32x32x16_bf16 v[16:31], v[104:107], v[40:43], v[16:31]
    ds_write_b128 v14, v[56:59] offset:2048
    ds_read_b64_tr_b16 v[104:105], v12 offset:4608
    ds_read_b64_tr_b16 v[106:107], v12 offset:4800
    ds_read_b128 v[40:43], v10 offset:8192
    s_waitcnt lgkmcnt(9)
    v_mfma_f32_32x32x16_bf16 v[16:31], v[108:111], v[44:47], v[16:31]
    ds_read_b64_tr_b16 v[108:109], v12 offset:5376
    ds_read_b64_tr_b16 v[110:111], v12 offset:5568
    ds_read_b128 v[44:47], v11 offset:8192
    s_waitcnt lgkmcnt(9)
    v_mfma_f32_32x32x16_bf16 v[16:31], v[96:99], v[32:35], v[16:31]
    ds_write_b128 v14, v[60:63] offset:3072
    ds_read_b64_tr_b16 v[96:97], v12 offset:6144
    ds_read_b64_tr_b16 v[98:99], v12 offset:6336
    ds_read_b128 v[32:35], v8 offset:16384
    s_waitcnt lgkmcnt(9)
    v_mfma_f32_32x32x16_bf16 v[16:31], v[100:103], v[36:39], v[16:31]
    ds_write_b128 v14, v[64:67] offset:4096
    ds_read_b64_tr_b16 v[100:101], v12 offset:6912
    ds_read_b64_tr_b16 v[102:103], v12 offset:7104
    ds_read_b128 v[36:39], v9 offset:16384
    s_waitcnt lgkmcnt(9)
    v_mfma_f32_32x32x16_bf16 v[16:31], v[104:107], v[40:43], v[16:31]
    ds_write_b128 v14, v[68:71] offset:5120
    ds_read_b64_tr_b16 v[104:105], v12 offset:7680
    ds_read_b64_tr_b16 v[106:107], v12 offset:7872
    ds_read_b128 v[40:43], v10 offset:16384
    s_waitcnt lgkmcnt(9)
    v_mfma_f32_32x32x16_bf16 v[16:31], v[108:111], v[44:47], v[16:31]
    ds_read_b64_tr_b16 v[108:109], v12 offset:8448
    ds_read_b64_tr_b16 v[110:111], v12 offset:8640
    ds_read_b128 v[44:47], v11 offset:16384
    s_waitcnt lgkmcnt(9)
    v_mfma_f32_32x32x16_bf16 v[16:31], v[96:99], v[32:35], v[16:31]
    ds_write_b128 v14, v[72:75] offset:6144
    ds_read_b64_tr_b16 v[96:97], v12 offset:9216
    ds_read_b64_tr_b16 v[98:99], v12 offset:9408
    ds_read_b128 v[32:35], v8 offset:24576
    s_waitcnt lgkmcnt(9)
    v_mfma_f32_32x32x16_bf16 v[16:31], v[100:103], v[36:39], v[16:31]
    ds_write_b128 v14, v[76:79] offset:7168
    ds_read_b64_tr_b16 v[100:101], v12 offset:9984
    ds_read_b64_tr_b16 v[102:103], v12 offset:10176
    ds_read_b128 v[36:39], v9 offset:24576
    s_waitcnt lgkmcnt(9)
    v_mfma_f32_32x32x16_bf16 v[16:31], v[104:107], v[40:43], v[16:31]
    ds_write_b128 v14, v[80:83] offset:8192
    ds_read_b64_tr_b16 v[104:105], v12 offset:10752
    ds_read_b64_tr_b16 v[106:107], v12 offset:10944
    ds_read_b128 v[40:43], v10 offset:24576
    s_waitcnt lgkmcnt(9)
    v_mfma_f32_32x32x16_bf16 v[16:31], v[108:111], v[44:47], v[16:31]
    ds_read_b64_tr_b16 v[108:109], v12 offset:11520
    ds_read_b64_tr_b16 v[110:111], v12 offset:11712
    ds_read_b128 v[44:47], v11 offset:24576
    s_waitcnt lgkmcnt(9)
    v_mfma_f32_32x32x16_bf16 v[16:31], v[96:99], v[32:35], v[16:31]
    ds_write_b128 v14, v[84:87] offset:9216
    ds_read_b64_tr_b16 v[96:97], v12 offset:12288
    ds_read_b64_tr_b16 v[98:99], v12 offset:12480
    ds_read_b128 v[32:35], v8 offset:32768
    s_waitcnt lgkmcnt(9)
    v_mfma_f32_32x32x16_bf16 v[16:31], v[100:103], v[36:39], v[16:31]
    ds_write_b128 v14, v[88:91] offset:10240
    ds_read_b64_tr_b16 v[100:101], v12 offset:13056
    ds_read_b64_tr_b16 v[102:103], v12 offset:13248
    ds_read_b128 v[36:39], v9 offset:32768
    s_waitcnt lgkmcnt(9)
    v_mfma_f32_32x32x16_bf16 v[16:31], v[104:107], v[40:43], v[16:31]
    ds_write_b128 v14, v[92:95] offset:11264
    ds_read_b64_tr_b16 v[104:105], v12 offset:13824
    ds_read_b64_tr_b16 v[106:107], v12 offset:14016
    ds_read_b128 v[40:43], v10 offset:32768
    s_waitcnt lgkmcnt(9)
    v_mfma_f32_32x32x16_bf16 v[16:31], v[108:111], v[44:47], v[16:31]
    ds_read_b64_tr_b16 v[108:109], v12 offset:14592
    ds_read_b64_tr_b16 v[110:111], v12 offset:14784
    ds_read_b128 v[44:47], v11 offset:32768
    s_waitcnt lgkmcnt(9)
    v_mfma_f32_32x32x16_bf16 v[16:31], v[96:99], v[32:35], v[16:31]
    ds_read_b64_tr_b16 v[96:97], v12 offset:0
    ds_read_b64_tr_b16 v[98:99], v12 offset:192
    ds_read_b128 v[32:35], v8 offset:40960
    s_waitcnt lgkmcnt(9)
    v_mfma_f32_32x32x16_bf16 v[16:31], v[100:103], v[36:39], v[16:31]
    ds_read_b64_tr_b16 v[100:101], v12 offset:768
    ds_read_b64_tr_b16 v[102:103], v12 offset:960
    ds_read_b128 v[36:39], v9 offset:40960
    s_waitcnt lgkmcnt(9)
    v_mfma_f32_32x32x16_bf16 v[16:31], v[104:107], v[40:43], v[16:31]
    ds_read_b64_tr_b16 v[104:105], v12 offset:1536
    ds_read_b64_tr_b16 v[106:107], v12 offset:1728
    ds_read_b128 v[40:43], v10 offset:40960
    s_waitcnt lgkmcnt(9)
    v_mfma_f32_32x32x16_bf16 v[16:31], v[108:111], v[44:47], v[16:31]
    ds_read_b64_tr_b16 v[108:109], v12 offset:2304
    ds_read_b64_tr_b16 v[110:111], v12 offset:2496
    ds_read_b128 v[44:47], v11 offset:40960
    s_waitcnt lgkmcnt(9)
    v_mfma_f32_32x32x16_bf16 v[16:31], v[96:99], v[32:35], v[16:31]
    ds_read_b64_tr_b16 v[96:97], v12 offset:3072
    ds_read_b64_tr_b16 v[98:99], v12 offset:3264
    ds_read_b128 v[32:35], v8 offset:49152
    s_waitcnt lgkmcnt(9)
    v_mfma_f32_32x32x16_bf16 v[16:31], v[100:103], v[36:39], v[16:31]
    ds_read_b64_tr_b16 v[100:101], v12 offset:3840
    ds_read_b64_tr_b16 v[102:103], v12 offset:4032
    ds_read_b128 v[36:39], v9 offset:49152
    s_waitcnt lgkmcnt(9)
    v_mfma_f32_32x32x16_bf16 v[16:31], v[104:107], v[40:43], v[16:31]
    ds_read_b64_tr_b16 v[104:105], v12 offset:4608
    ds_read_b64_tr_b16 v[106:107], v12 offset:4800
    ds_read_b128 v[40:43], v10 offset:49152
    s_waitcnt lgkmcnt(9)
    v_mfma_f32_32x32x16_bf16 v[16:31], v[108:111], v[44:47], v[16:31]
    ds_read_b64_tr_b16 v[108:109], v12 offset:5376
    ds_read_b64_tr_b16 v[110:111], v12 offset:5568
    ds_read_b128 v[44:47], v11 offset:49152
    s_waitcnt lgkmcnt(9)
    v_mfma_f32_32x32x16_bf16 v[16:31], v[96:99], v[32:35], v[16:31]
    ds_read_b64_tr_b16 v[96:97], v12 offset:6144
    ds_read_b64_tr_b16 v[98:99], v12 offset:6336
    ds_read_b128 v[32:35], v8 offset:57344
    s_waitcnt lgkmcnt(9)
    v_mfma_f32_32x32x16_bf16 v[16:31], v[100:103], v[36:39], v[16:31]
    ds_read_b64_tr_b16 v[100:101], v12 offset:6912
    ds_read_b64_tr_b16 v[102:103], v12 offset:7104
    ds_read_b128 v[36:39], v9 offset:57344
    s_waitcnt lgkmcnt(9)
    v_mfma_f32_32x32x16_bf16 v[16:31], v[104:107], v[40:43], v[16:31]
    ds_read_b64_tr_b16 v[104:105], v12 offset:7680
    ds_read_b64_tr_b16 v[106:107], v12 offset:7872
    ds_read_b128 v[40:43], v10 offset:57344
    s_waitcnt lgkmcnt(9)
    v_mfma_f32_32x32x16_bf16 v[16:31], v[108:111], v[44:47], v[16:31]
    ds_read_b64_tr_b16 v[108:109], v12 offset:8448
    ds_read_b64_tr_b16 v[110:111], v12 offset:8640
    ds_read_b128 v[44:47], v11 offset:57344
    s_waitcnt lgkmcnt(9)
    v_mfma_f32_32x32x16_bf16 v[16:31], v[96:99], v[32:35], v[16:31]
    ds_read_b64_tr_b16 v[96:97], v12 offset:9216
    ds_read_b64_tr_b16 v[98:99], v12 offset:9408
    ds_read_b128 v[32:35], v112
    s_waitcnt lgkmcnt(9)
    v_mfma_f32_32x32x16_bf16 v[16:31], v[100:103], v[36:39], v[16:31]
    ds_read_b64_tr_b16 v[100:101], v12 offset:9984
    ds_read_b64_tr_b16 v[102:103], v12 offset:10176
    ds_read_b128 v[36:39], v113
    s_waitcnt lgkmcnt(9)
    v_mfma_f32_32x32x16_bf16 v[16:31], v[104:107], v[40:43], v[16:31]
    ds_read_b64_tr_b16 v[104:105], v12 offset:10752
    ds_read_b64_tr_b16 v[106:107], v12 offset:10944
    ds_read_b128 v[40:43], v114
    s_waitcnt lgkmcnt(9)
    v_mfma_f32_32x32x16_bf16 v[16:31], v[108:111], v[44:47], v[16:31]
    ds_read_b64_tr_b16 v[108:109], v12 offset:11520
    ds_read_b64_tr_b16 v[110:111], v12 offset:11712
    ds_read_b128 v[44:47], v115
    s_waitcnt lgkmcnt(9)
    v_mfma_f32_32x32x16_bf16 v[16:31], v[96:99], v[32:35], v[16:31]
    s_waitcnt lgkmcnt(6)
    v_mfma_f32_32x32x16_bf16 v[16:31], v[100:103], v[36:39], v[16:31]
    s_waitcnt lgkmcnt(3)
    v_mfma_f32_32x32x16_bf16 v[16:31], v[104:107], v[40:43], v[16:31]
    s_waitcnt lgkmcnt(0)
    v_mfma_f32_32x32x16_bf16 v[16:31], v[108:111], v[44:47], v[16:31]
    s_branch KVJ_200
KVV_199:
    s_waitcnt lgkmcnt(9)
    v_mfma_f32_32x32x16_bf16 v[16:31], v[32:35], v[96:99], v[16:31]
    ds_write_b128 v14, v[48:51] offset:0
    ds_read_b64_tr_b16 v[96:97], v12 offset:3072
    ds_read_b64_tr_b16 v[98:99], v12 offset:3264
    ds_read_b128 v[32:35], v8 offset:8192
    s_waitcnt lgkmcnt(9)
    v_mfma_f32_32x32x16_bf16 v[16:31], v[36:39], v[100:103], v[16:31]
    ds_write_b128 v14, v[52:55] offset:1024
    ds_read_b64_tr_b16 v[100:101], v12 offset:3840
    ds_read_b64_tr_b16 v[102:103], v12 offset:4032
    ds_read_b128 v[36:39], v9 offset:8192
    s_waitcnt lgkmcnt(9)
    v_mfma_f32_32x32x16_bf16 v[16:31], v[40:43], v[104:107], v[16:31]
    ds_write_b128 v14, v[56:59] offset:2048
    ds_read_b64_tr_b16 v[104:105], v12 offset:4608
    ds_read_b64_tr_b16 v[106:107], v12 offset:4800
    ds_read_b128 v[40:43], v10 offset:8192
    s_waitcnt lgkmcnt(9)
    v_mfma_f32_32x32x16_bf16 v[16:31], v[44:47], v[108:111], v[16:31]
    ds_read_b64_tr_b16 v[108:109], v12 offset:5376
    ds_read_b64_tr_b16 v[110:111], v12 offset:5568
    ds_read_b128 v[44:47], v11 offset:8192
    s_waitcnt lgkmcnt(9)
    v_mfma_f32_32x32x16_bf16 v[16:31], v[32:35], v[96:99], v[16:31]
    ds_write_b128 v14, v[60:63] offset:3072
    ds_read_b64_tr_b16 v[96:97], v12 offset:6144
    ds_read_b64_tr_b16 v[98:99], v12 offset:6336
    ds_read_b128 v[32:35], v8 offset:16384
    s_waitcnt lgkmcnt(9)
    v_mfma_f32_32x32x16_bf16 v[16:31], v[36:39], v[100:103], v[16:31]
    ds_write_b128 v14, v[64:67] offset:4096
    ds_read_b64_tr_b16 v[100:101], v12 offset:6912
    ds_read_b64_tr_b16 v[102:103], v12 offset:7104
    ds_read_b128 v[36:39], v9 offset:16384
    s_waitcnt lgkmcnt(9)
    v_mfma_f32_32x32x16_bf16 v[16:31], v[40:43], v[104:107], v[16:31]
    ds_write_b128 v14, v[68:71] offset:5120
    ds_read_b64_tr_b16 v[104:105], v12 offset:7680
    ds_read_b64_tr_b16 v[106:107], v12 offset:7872
    ds_read_b128 v[40:43], v10 offset:16384
    s_waitcnt lgkmcnt(9)
    v_mfma_f32_32x32x16_bf16 v[16:31], v[44:47], v[108:111], v[16:31]
    ds_read_b64_tr_b16 v[108:109], v12 offset:8448
    ds_read_b64_tr_b16 v[110:111], v12 offset:8640
    ds_read_b128 v[44:47], v11 offset:16384
    s_waitcnt lgkmcnt(9)
    v_mfma_f32_32x32x16_bf16 v[16:31], v[32:35], v[96:99], v[16:31]
    ds_write_b128 v14, v[72:75] offset:6144
    ds_read_b64_tr_b16 v[96:97], v12 offset:9216
    ds_read_b64_tr_b16 v[98:99], v12 offset:9408
    ds_read_b128 v[32:35], v8 offset:24576
    s_waitcnt lgkmcnt(9)
    v_mfma_f32_32x32x16_bf16 v[16:31], v[36:39], v[100:103], v[16:31]
    ds_write_b128 v14, v[76:79] offset:7168
    ds_read_b64_tr_b16 v[100:101], v12 offset:9984
    ds_read_b64_tr_b16 v[102:103], v12 offset:10176
    ds_read_b128 v[36:39], v9 offset:24576
    s_waitcnt lgkmcnt(9)
    v_mfma_f32_32x32x16_bf16 v[16:31], v[40:43], v[104:107], v[16:31]
    ds_write_b128 v14, v[80:83] offset:8192
    ds_read_b64_tr_b16 v[104:105], v12 offset:10752
    ds_read_b64_tr_b16 v[106:107], v12 offset:10944
    ds_read_b128 v[40:43], v10 offset:24576
    s_waitcnt lgkmcnt(9)
    v_mfma_f32_32x32x16_bf16 v[16:31], v[44:47], v[108:111], v[16:31]
    ds_read_b64_tr_b16 v[108:109], v12 offset:11520
    ds_read_b64_tr_b16 v[110:111], v12 offset:11712
    ds_read_b128 v[44:47], v11 offset:24576
    s_waitcnt lgkmcnt(9)
    v_mfma_f32_32x32x16_bf16 v[16:31], v[32:35], v[96:99], v[16:31]
    ds_write_b128 v14, v[84:87] offset:9216
    ds_read_b64_tr_b16 v[96:97], v12 offset:12288
    ds_read_b64_tr_b16 v[98:99], v12 offset:12480
    ds_read_b128 v[32:35], v8 offset:32768
    s_waitcnt lgkmcnt(9)
    v_mfma_f32_32x32x16_bf16 v[16:31], v[36:39], v[100:103], v[16:31]
    ds_write_b128 v14, v[88:91] offset:10240
    ds_read_b64_tr_b16 v[100:101], v12 offset:13056
    ds_read_b64_tr_b16 v[102:103], v12 offset:13248
    ds_read_b128 v[36:39], v9 offset:32768
    s_waitcnt lgkmcnt(9)
    v_mfma_f32_32x32x16_bf16 v[16:31], v[40:43], v[104:107], v[16:31]
    ds_write_b128 v14, v[92:95] offset:11264
    ds_read_b64_tr_b16 v[104:105], v12 offset:13824
    ds_read_b64_tr_b16 v[106:107], v12 offset:14016
    ds_read_b128 v[40:43], v10 offset:32768
    s_waitcnt lgkmcnt(9)
    v_mfma_f32_32x32x16_bf16 v[16:31], v[44:47], v[108:111], v[16:31]
    ds_read_b64_tr_b16 v[108:109], v12 offset:14592
    ds_read_b64_tr_b16 v[110:111], v12 offset:14784
    ds_read_b128 v[44:47], v11 offset:32768
    s_waitcnt lgkmcnt(9)
    v_mfma_f32_32x32x16_bf16 v[16:31], v[32:35], v[96:99], v[16:31]
    ds_read_b64_tr_b16 v[96:97], v12 offset:0
    ds_read_b64_tr_b16 v[98:99], v12 offset:192
    ds_read_b128 v[32:35], v8 offset:40960
    s_waitcnt lgkmcnt(9)
    v_mfma_f32_32x32x16_bf16 v[16:31], v[36:39], v[100:103], v[16:31]
    ds_read_b64_tr_b16 v[100:101], v12 offset:768
    ds_read_b64_tr_b16 v[102:103], v12 offset:960
    ds_read_b128 v[36:39], v9 offset:40960
    s_waitcnt lgkmcnt(9)
    v_mfma_f32_32x32x16_bf16 v[16:31], v[40:43], v[104:107], v[16:31]
    ds_read_b64_tr_b16 v[104:105], v12 offset:1536
    ds_read_b64_tr_b16 v[106:107], v12 offset:1728
    ds_read_b128 v[40:43], v10 offset:40960
    s_waitcnt lgkmcnt(9)
    v_mfma_f32_32x32x16_bf16 v[16:31], v[44:47], v[108:111], v[16:31]
    ds_read_b64_tr_b16 v[108:109], v12 offset:2304
    ds_read_b64_tr_b16 v[110:111], v12 offset:2496
    ds_read_b128 v[44:47], v11 offset:40960
    s_waitcnt lgkmcnt(9)
    v_mfma_f32_32x32x16_bf16 v[16:31], v[32:35], v[96:99], v[16:31]
    ds_read_b64_tr_b16 v[96:97], v12 offset:3072
    ds_read_b64_tr_b16 v[98:99], v12 offset:3264
    ds_read_b128 v[32:35], v8 offset:49152
    s_waitcnt lgkmcnt(9)
    v_mfma_f32_32x32x16_bf16 v[16:31], v[36:39], v[100:103], v[16:31]
    ds_read_b64_tr_b16 v[100:101], v12 offset:3840
    ds_read_b64_tr_b16 v[102:103], v12 offset:4032
    ds_read_b128 v[36:39], v9 offset:49152
    s_waitcnt lgkmcnt(9)
    v_mfma_f32_32x32x16_bf16 v[16:31], v[40:43], v[104:107], v[16:31]
    ds_read_b64_tr_b16 v[104:105], v12 offset:4608
    ds_read_b64_tr_b16 v[106:107], v12 offset:4800
    ds_read_b128 v[40:43], v10 offset:49152
    s_waitcnt lgkmcnt(9)
    v_mfma_f32_32x32x16_bf16 v[16:31], v[44:47], v[108:111], v[16:31]
    ds_read_b64_tr_b16 v[108:109], v12 offset:5376
    ds_read_b64_tr_b16 v[110:111], v12 offset:5568
    ds_read_b128 v[44:47], v11 offset:49152
    s_waitcnt lgkmcnt(9)
    v_mfma_f32_32x32x16_bf16 v[16:31], v[32:35], v[96:99], v[16:31]
    ds_read_b64_tr_b16 v[96:97], v12 offset:6144
    ds_read_b64_tr_b16 v[98:99], v12 offset:6336
    ds_read_b128 v[32:35], v8 offset:57344
    s_waitcnt lgkmcnt(9)
    v_mfma_f32_32x32x16_bf16 v[16:31], v[36:39], v[100:103], v[16:31]
    ds_read_b64_tr_b16 v[100:101], v12 offset:6912
    ds_read_b64_tr_b16 v[102:103], v12 offset:7104
    ds_read_b128 v[36:39], v9 offset:57344
    s_waitcnt lgkmcnt(9)
    v_mfma_f32_32x32x16_bf16 v[16:31], v[40:43], v[104:107], v[16:31]
    ds_read_b64_tr_b16 v[104:105], v12 offset:7680
    ds_read_b64_tr_b16 v[106:107], v12 offset:7872
    ds_read_b128 v[40:43], v10 offset:57344
    s_waitcnt lgkmcnt(9)
    v_mfma_f32_32x32x16_bf16 v[16:31], v[44:47], v[108:111], v[16:31]
    ds_read_b64_tr_b16 v[108:109], v12 offset:8448
    ds_read_b64_tr_b16 v[110:111], v12 offset:8640
    ds_read_b128 v[44:47], v11 offset:57344
    s_waitcnt lgkmcnt(9)
    v_mfma_f32_32x32x16_bf16 v[16:31], v[32:35], v[96:99], v[16:31]
    ds_read_b64_tr_b16 v[96:97], v12 offset:9216
    ds_read_b64_tr_b16 v[98:99], v12 offset:9408
    ds_read_b128 v[32:35], v112
    s_waitcnt lgkmcnt(9)
    v_mfma_f32_32x32x16_bf16 v[16:31], v[36:39], v[100:103], v[16:31]
    ds_read_b64_tr_b16 v[100:101], v12 offset:9984
    ds_read_b64_tr_b16 v[102:103], v12 offset:10176
    ds_read_b128 v[36:39], v113
    s_waitcnt lgkmcnt(9)
    v_mfma_f32_32x32x16_bf16 v[16:31], v[40:43], v[104:107], v[16:31]
    ds_read_b64_tr_b16 v[104:105], v12 offset:10752
    ds_read_b64_tr_b16 v[106:107], v12 offset:10944
    ds_read_b128 v[40:43], v114
    s_waitcnt lgkmcnt(9)
    v_mfma_f32_32x32x16_bf16 v[16:31], v[44:47], v[108:111], v[16:31]
    ds_read_b64_tr_b16 v[108:109], v12 offset:11520
    ds_read_b64_tr_b16 v[110:111], v12 offset:11712
    ds_read_b128 v[44:47], v115
    s_waitcnt lgkmcnt(9)
    v_mfma_f32_32x32x16_bf16 v[16:31], v[32:35], v[96:99], v[16:31]
    s_waitcnt lgkmcnt(6)
    v_mfma_f32_32x32x16_bf16 v[16:31], v[36:39], v[100:103], v[16:31]
    s_waitcnt lgkmcnt(3)
    v_mfma_f32_32x32x16_bf16 v[16:31], v[40:43], v[104:107], v[16:31]
    s_waitcnt lgkmcnt(0)
    v_mfma_f32_32x32x16_bf16 v[16:31], v[44:47], v[108:111], v[16:31]
KVJ_200:
    s_lshl_b32 s63, s4, 1
    s_add_u32 s63, s63, s87
    s_mov_b32 s62, s86
    s_add_u32 s52, s40, 0
    s_addc_u32 s53, s41, 0
    s_mov_b32 s54, 151552
    s_mov_b32 s55, 0x20000
    s_lshr_b32 s67, s63, 2
    s_mul_i32 s67, s67, 9472
    s_and_b32 s68, s63, 3
    s_nop 7
    v_cvt_pk_bf16_f32 v32, v16, v17
    v_cvt_pk_bf16_f32 v33, v18, v19
    v_cvt_pk_bf16_f32 v34, v20, v21
    v_cvt_pk_bf16_f32 v35, v22, v23
    v_cvt_pk_bf16_f32 v36, v24, v25
    v_cvt_pk_bf16_f32 v37, v26, v27
    v_cvt_pk_bf16_f32 v38, v28, v29
    v_cvt_pk_bf16_f32 v39, v30, v31
    s_cmp_eq_u32 s62, 0
    s_cbranch_scc0 KVEV_201
    s_lshl_b32 s69, s68, 10
    s_add_u32 s69, s69, s67
    v_lshlrev_b32 v7, 4, v0
    buffer_store_dwordx4 v[32:35], v7, s[52:55], s69 offen sc1
    s_lshl_b32 s69, s68, 7
    s_add_u32 s69, s69, s67
    s_add_u32 s69, s69, 4096
    v_lshlrev_b32 v8, 2, v0
    s_mov_b32 exec_hi, 0
    buffer_store_dword v36, v8, s[52:55], s69 offen sc1
    s_mov_b64 exec, -1
    s_branch KVEJ_202
KVEV_201:
    s_mul_i32 s69, s68, 1216
    s_add_u32 s69, s69, s67
    s_add_u32 s69, s69, 4608
    v_and_b32 v7, 31, v0
    v_cmp_eq_u32 vcc, 18, v7
    v_mov_b32 v9, 0x3f803f80
    v_lshrrev_b32 v8, 5, v0
    v_mul_u32_u24 v8, 304, v8
    v_lshl_add_u32 v8, v7, 4, v8
    v_cndmask_b32 v32, v32, v9, vcc
    v_cndmask_b32 v33, v33, v9, vcc
    v_cndmask_b32 v34, v34, v9, vcc
    v_cndmask_b32 v35, v35, v9, vcc
    v_cndmask_b32 v36, v36, v9, vcc
    v_cndmask_b32 v37, v37, v9, vcc
    v_cndmask_b32 v38, v38, v9, vcc
    v_cndmask_b32 v39, v39, v9, vcc
    s_nop 1
    v_permlane32_swap_b32 v32, v34
    v_permlane32_swap_b32 v33, v35
    v_permlane32_swap_b32 v36, v38
    v_permlane32_swap_b32 v37, v39
    s_mov_b32 exec_lo, 0x7ffff
    s_mov_b32 exec_hi, 0x7ffff
    buffer_store_dwordx4 v[32:35], v8, s[52:55], s69 offen offset:0 sc1
    buffer_store_dwordx4 v[36:39], v8, s[52:55], s69 offen offset:608 sc1
    s_mov_b64 exec, -1
KVEJ_202:
    v_mov_b32 v254, 0
    s_mov_b32 s91, 400000
    s_mov_b64 exec, 1
RW_203:
    global_load_dword v255, v254, s[38:39] sc1
    s_waitcnt vmcnt(0)
    v_cmp_eq_u32 vcc, 0, v255
    s_cbranch_vccz RWD_204
    s_sub_u32 s91, s91, 1
    s_cbranch_scc1 RWD_204
    s_sleep 8
    s_branch RW_203
RWD_204:
    s_mov_b64 exec, -1
    s_add_u32 s60, s6, 16
    s_lshl_b32 s90, s60, 7
    s_add_u32 s90, s90, 196608
    s_add_u32 s74, s40, s90
    s_addc_u32 s75, s41, 0
    s_mov_b32 s89, 1
    s_atomic_add s89, s[74:75], 0 glc
    s_lshl_b32 s90, 64, 7
    s_add_u32 s90, s90, 196608
    v_lshl_add_u32 v254, v0, 7, s90
    v_mov_b32 v255, 1
    s_waitcnt lgkmcnt(0)
    s_cmp_lg_u32 s89, 15
    s_cbranch_scc1 GA_205
    s_mov_b32 exec_lo, 0xffffffff
    s_mov_b32 exec_hi, 0
    global_atomic_add v254, v255, s[40:41] sc1
    s_mov_b64 exec, -1
GA_205:
    s_branch K_CV
K_KG:
    s_xor_b32 s60, s2, 8
    s_or_b32 s60, s60, s3
    s_cbranch_scc1 K_KG1
    v_mov_b32 v5, 1
    s_waitcnt vmcnt(1)
    s_mov_b64 exec, 1
    global_store_dword v4, v5, s[38:39] sc1
    s_mov_b64 exec, -1
K_KG1:
    s_setprio 0
    s_lshl_b32 s60, s85, 8
    v_lshl_add_u32 v12, v0, 2, s60
    s_lshl_b32 s60, s85, 1
    v_mov_b32 v13, s60
    global_load_ushort v8, v13, s[32:33]
    global_load_dword v2, v12, s[20:21]
    global_load_dword v3, v12, s[22:23]
    global_load_dword v4, v12, s[24:25]
    global_load_dword v5, v12, s[26:27]
    global_load_dword v6, v12, s[28:29]
    global_load_dword v7, v12, s[30:31]
    global_load_ushort v9, v13, s[34:35]
    v_and_b32 v14, 1, v0
    v_bfe_u32 v15, v0, 2, 1
    v_lshl_or_b32 v14, v15, 1, v14
    v_bfe_u32 v15, v0, 1, 1
    v_lshl_or_b32 v14, v15, 2, v14
    v_lshlrev_b32 v32, 7, v0
    v_lshl_add_u32 v32, v14, 4, v32
    v_add_u32 v32, s84, v32
    v_xor_b32 v33, 16, v32
    v_xor_b32 v34, 32, v32
    v_xor_b32 v35, 48, v32
    v_xor_b32 v36, 64, v32
    v_xor_b32 v37, 80, v32
    v_xor_b32 v38, 96, v32
    v_xor_b32 v39, 112, v32
    v_bfe_u32 v16, v0, 2, 2
    v_lshrrev_b32 v17, 5, v0
    v_lshl_add_u32 v16, v17, 2, v16
    v_and_b32 v14, 1, v16
    v_bfe_u32 v15, v16, 2, 1
    v_lshl_or_b32 v14, v15, 1, v14
    v_bfe_u32 v15, v16, 1, 1
    v_lshl_or_b32 v14, v15, 2, v14
    v_bfe_u32 v17, v0, 4, 1
    v_bfe_u32 v15, v0, 1, 1
    v_lshl_add_u32 v17, v17, 1, v15
    v_xor_b32 v14, v14, v17
    v_lshlrev_b32 v11, 7, v16
    v_lshl_add_u32 v11, v14, 4, v11
    v_and_b32 v15, 1, v0
    v_lshl_add_u32 v11, v15, 3, v11
    v_add_u32 v11, s84, v11
    v_xor_b32 v10, 64, v11
    v_mov_b32 v28, 1.0
    v_mov_b32 v29, 0
    v_mov_b32 v144, 0
    v_mov_b32 v145, 0
    v_mov_b32 v146, 0
    v_mov_b32 v147, 0
    v_mov_b32 v148, 0
    v_mov_b32 v149, 0
    v_mov_b32 v150, 0
    v_mov_b32 v151, 0
    v_mov_b32 v152, 0
    v_mov_b32 v153, 0
    v_mov_b32 v154, 0
    v_mov_b32 v155, 0
    v_mov_b32 v156, 0
    v_mov_b32 v157, 0
    v_mov_b32 v158, 0
    v_mov_b32 v159, 0
    s_mov_b32 s61, 0x3fb8aa3b
    s_mov_b32 s62, 2
    s_waitcnt vmcnt(7)
    v_lshlrev_b32 v8, 16, v8
    v_mul_f32 v8, s61, v8
    v_exp_f32 v8, v8
    s_waitcnt vmcnt(0)
    v_cvt_pk_bf16_f32 v8, v8, v8
    v_and_b32 v8, 0xffff0000, v8
KGP_206:
    v_lshlrev_b32 v12, 16, v2
    v_lshlrev_b32 v13, 16, v3
    v_lshlrev_b32 v14, 16, v4
    v_lshlrev_b32 v15, 16, v5
    v_lshlrev_b32 v16, 16, v6
    v_lshlrev_b32 v17, 16, v7
    v_mul_f32 v12, v8, v12
    v_mul_f32 v13, v8, v13
    v_mul_f32 v14, v8, v14
    v_mul_f32 v15, v8, v15
    v_mul_f32 v12, s61, v12
    v_mul_f32 v13, 0.15915494, v13
    v_mul_f32 v128, 0x41000000, v12
    v_mul_f32 v129, 0x41000000, v13
    v_mul_f32 v130, 0x43800000, v12
    v_mul_f32 v131, 0x43800000, v13
    v_fract_f32 v129, v129
    v_fract_f32 v131, v131
    v_fract_f32 v13, v13
    v_exp_f32 v128, v128
    v_cos_f32 v42, v129
    v_sin_f32 v43, v129
    v_exp_f32 v12, v12
    v_cos_f32 v20, v13
    v_sin_f32 v21, v13
    v_exp_f32 v130, v130
    v_cos_f32 v22, v131
    v_sin_f32 v23, v131
    v_lshrrev_b32 v2, 16, v2
    v_lshrrev_b32 v3, 16, v3
    v_lshrrev_b32 v4, 16, v4
    v_lshrrev_b32 v5, 16, v5
    v_lshrrev_b32 v6, 16, v6
    v_lshrrev_b32 v7, 16, v7
    v_mul_f32 v42, v42, v128
    v_mul_f32 v43, v43, v128
    v_mul_f32 v20, v20, v12
    v_mul_f32 v21, v21, v12
    v_mul_f32 v22, v22, v130
    v_mul_f32 v23, v23, v130
    v_pk_mul_f32 v[72:73], v[16:17], v[14:15] op_sel:[0,0] op_sel_hi:[1,0]
    v_pk_mul_f32 v[44:45], v[42:43], v[42:43] op_sel:[0,0] op_sel_hi:[1,0]
    v_pk_mul_f32 v[24:25], v[20:21], v[20:21] op_sel:[0,0] op_sel_hi:[1,0]
    v_pk_fma_f32 v[72:73], v[16:17], v[14:15], v[72:73] op_sel:[1,1,0] op_sel_hi:[0,1,1] neg_lo:[1,0,0]
    v_pk_fma_f32 v[44:45], v[42:43], v[42:43], v[44:45] op_sel:[1,1,0] op_sel_hi:[0,1,1] neg_lo:[1,0,0]
    v_pk_fma_f32 v[24:25], v[20:21], v[20:21], v[24:25] op_sel:[1,1,0] op_sel_hi:[0,1,1] neg_lo:[1,0,0]
    v_pk_mul_f32 v[48:49], v[44:45], v[44:45] op_sel:[0,0] op_sel_hi:[1,0]
    v_pk_mul_f32 v[46:47], v[44:45], v[42:43] op_sel:[0,0] op_sel_hi:[1,0]
    v_pk_mul_f32 v[74:75], v[72:73], v[20:21] op_sel:[0,0] op_sel_hi:[1,0]
    v_pk_mul_f32 v[76:77], v[72:73], v[24:25] op_sel:[0,0] op_sel_hi:[1,0]
    v_pk_mul_f32 v[88:89], v[72:73], v[42:43] op_sel:[0,0] op_sel_hi:[1,0]
    v_pk_mul_f32 v[90:91], v[72:73], v[22:23] op_sel:[0,0] op_sel_hi:[1,0]
    v_pk_fma_f32 v[48:49], v[44:45], v[44:45], v[48:49] op_sel:[1,1,0] op_sel_hi:[0,1,1] neg_lo:[1,0,0]
    v_pk_fma_f32 v[46:47], v[44:45], v[42:43], v[46:47] op_sel:[1,1,0] op_sel_hi:[0,1,1] neg_lo:[1,0,0]
    v_pk_fma_f32 v[74:75], v[72:73], v[20:21], v[74:75] op_sel:[1,1,0] op_sel_hi:[0,1,1] neg_lo:[1,0,0]
    v_pk_fma_f32 v[76:77], v[72:73], v[24:25], v[76:77] op_sel:[1,1,0] op_sel_hi:[0,1,1] neg_lo:[1,0,0]
    v_pk_fma_f32 v[88:89], v[72:73], v[42:43], v[88:89] op_sel:[1,1,0] op_sel_hi:[0,1,1] neg_lo:[1,0,0]
    v_pk_fma_f32 v[90:91], v[72:73], v[22:23], v[90:91] op_sel:[1,1,0] op_sel_hi:[0,1,1] neg_lo:[1,0,0]
    v_pk_mul_f32 v[26:27], v[48:49], v[48:49] op_sel:[0,0] op_sel_hi:[1,0]
    v_pk_mul_f32 v[50:51], v[48:49], v[42:43] op_sel:[0,0] op_sel_hi:[1,0]
    v_pk_mul_f32 v[52:53], v[48:49], v[44:45] op_sel:[0,0] op_sel_hi:[1,0]
    v_pk_mul_f32 v[54:55], v[48:49], v[46:47] op_sel:[0,0] op_sel_hi:[1,0]
    v_pk_mul_f32 v[78:79], v[74:75], v[24:25] op_sel:[0,0] op_sel_hi:[1,0]
    v_pk_mul_f32 v[80:81], v[76:77], v[24:25] op_sel:[0,0] op_sel_hi:[1,0]
    v_pk_mul_f32 v[92:93], v[76:77], v[22:23] op_sel:[0,0] op_sel_hi:[1,0]
    v_pk_mul_f32 v[98:99], v[88:89], v[22:23] op_sel:[0,0] op_sel_hi:[1,0]
    v_pk_mul_f32 v[100:101], v[90:91], v[22:23] op_sel:[0,0] op_sel_hi:[1,0]
    v_pk_fma_f32 v[26:27], v[48:49], v[48:49], v[26:27] op_sel:[1,1,0] op_sel_hi:[0,1,1] neg_lo:[1,0,0]
    v_pk_fma_f32 v[50:51], v[48:49], v[42:43], v[50:51] op_sel:[1,1,0] op_sel_hi:[0,1,1] neg_lo:[1,0,0]
    v_pk_fma_f32 v[52:53], v[48:49], v[44:45], v[52:53] op_sel:[1,1,0] op_sel_hi:[0,1,1] neg_lo:[1,0,0]
    v_pk_fma_f32 v[54:55], v[48:49], v[46:47], v[54:55] op_sel:[1,1,0] op_sel_hi:[0,1,1] neg_lo:[1,0,0]
    v_pk_fma_f32 v[78:79], v[74:75], v[24:25], v[78:79] op_sel:[1,1,0] op_sel_hi:[0,1,1] neg_lo:[1,0,0]
    v_pk_fma_f32 v[80:81], v[76:77], v[24:25], v[80:81] op_sel:[1,1,0] op_sel_hi:[0,1,1] neg_lo:[1,0,0]
    v_pk_fma_f32 v[92:93], v[76:77], v[22:23], v[92:93] op_sel:[1,1,0] op_sel_hi:[0,1,1] neg_lo:[1,0,0]
    v_pk_fma_f32 v[98:99], v[88:89], v[22:23], v[98:99] op_sel:[1,1,0] op_sel_hi:[0,1,1] neg_lo:[1,0,0]
    v_pk_fma_f32 v[100:101], v[90:91], v[22:23], v[100:101] op_sel:[1,1,0] op_sel_hi:[0,1,1] neg_lo:[1,0,0]
    v_cvt_pk_bf16_f32 v128, v28, v42
    v_cvt_pk_bf16_f32 v129, v44, v46
    v_cvt_pk_bf16_f32 v130, v48, v50
    v_cvt_pk_bf16_f32 v131, v52, v54
    v_cvt_pk_bf16_f32 v132, v29, v43
    v_cvt_pk_bf16_f32 v133, v45, v47
    v_cvt_pk_bf16_f32 v134, v49, v51
    v_cvt_pk_bf16_f32 v135, v53, v55
    ds_write_b128 v32, v[128:131]
    ds_write_b128 v32, v[132:135] offset:8192
    v_pk_mul_f32 v[58:59], v[42:43], v[26:27] op_sel:[0,0] op_sel_hi:[1,0]
    v_pk_mul_f32 v[60:61], v[44:45], v[26:27] op_sel:[0,0] op_sel_hi:[1,0]
    v_pk_mul_f32 v[62:63], v[46:47], v[26:27] op_sel:[0,0] op_sel_hi:[1,0]
    v_pk_mul_f32 v[64:65], v[48:49], v[26:27] op_sel:[0,0] op_sel_hi:[1,0]
    v_pk_mul_f32 v[66:67], v[50:51], v[26:27] op_sel:[0,0] op_sel_hi:[1,0]
    v_pk_mul_f32 v[68:69], v[52:53], v[26:27] op_sel:[0,0] op_sel_hi:[1,0]
    v_pk_mul_f32 v[70:71], v[54:55], v[26:27] op_sel:[0,0] op_sel_hi:[1,0]
    v_pk_mul_f32 v[82:83], v[78:79], v[24:25] op_sel:[0,0] op_sel_hi:[1,0]
    v_pk_mul_f32 v[84:85], v[80:81], v[24:25] op_sel:[0,0] op_sel_hi:[1,0]
    v_pk_mul_f32 v[94:95], v[80:81], v[22:23] op_sel:[0,0] op_sel_hi:[1,0]
    v_pk_mul_f32 v[104:105], v[98:99], v[22:23] op_sel:[0,0] op_sel_hi:[1,0]
    v_pk_mul_f32 v[106:107], v[100:101], v[22:23] op_sel:[0,0] op_sel_hi:[1,0]
    v_pk_fma_f32 v[58:59], v[42:43], v[26:27], v[58:59] op_sel:[1,1,0] op_sel_hi:[0,1,1] neg_lo:[1,0,0]
    v_pk_fma_f32 v[60:61], v[44:45], v[26:27], v[60:61] op_sel:[1,1,0] op_sel_hi:[0,1,1] neg_lo:[1,0,0]
    v_pk_fma_f32 v[62:63], v[46:47], v[26:27], v[62:63] op_sel:[1,1,0] op_sel_hi:[0,1,1] neg_lo:[1,0,0]
    v_pk_fma_f32 v[64:65], v[48:49], v[26:27], v[64:65] op_sel:[1,1,0] op_sel_hi:[0,1,1] neg_lo:[1,0,0]
    v_pk_fma_f32 v[66:67], v[50:51], v[26:27], v[66:67] op_sel:[1,1,0] op_sel_hi:[0,1,1] neg_lo:[1,0,0]
    v_pk_fma_f32 v[68:69], v[52:53], v[26:27], v[68:69] op_sel:[1,1,0] op_sel_hi:[0,1,1] neg_lo:[1,0,0]
    v_pk_fma_f32 v[70:71], v[54:55], v[26:27], v[70:71] op_sel:[1,1,0] op_sel_hi:[0,1,1] neg_lo:[1,0,0]
    v_pk_fma_f32 v[82:83], v[78:79], v[24:25], v[82:83] op_sel:[1,1,0] op_sel_hi:[0,1,1] neg_lo:[1,0,0]
    v_pk_fma_f32 v[84:85], v[80:81], v[24:25], v[84:85] op_sel:[1,1,0] op_sel_hi:[0,1,1] neg_lo:[1,0,0]
    v_pk_fma_f32 v[94:95], v[80:81], v[22:23], v[94:95] op_sel:[1,1,0] op_sel_hi:[0,1,1] neg_lo:[1,0,0]
    v_pk_fma_f32 v[104:105], v[98:99], v[22:23], v[104:105] op_sel:[1,1,0] op_sel_hi:[0,1,1] neg_lo:[1,0,0]
    v_pk_fma_f32 v[106:107], v[100:101], v[22:23], v[106:107] op_sel:[1,1,0] op_sel_hi:[0,1,1] neg_lo:[1,0,0]
    v_cvt_pk_bf16_f32 v136, v26, v58
    v_cvt_pk_bf16_f32 v137, v60, v62
    v_cvt_pk_bf16_f32 v138, v64, v66
    v_cvt_pk_bf16_f32 v139, v68, v70
    v_cvt_pk_bf16_f32 v140, v27, v59
    v_cvt_pk_bf16_f32 v141, v61, v63
    v_cvt_pk_bf16_f32 v142, v65, v67
    v_cvt_pk_bf16_f32 v143, v69, v71
    ds_write_b128 v33, v[136:139]
    ds_write_b128 v33, v[140:143] offset:8192
    v_cvt_pk_bf16_f32 v128, v72, v74
    v_cvt_pk_bf16_f32 v129, v76, v78
    v_cvt_pk_bf16_f32 v130, v90, v90
    v_cvt_pk_bf16_f32 v131, v92, v94
    v_cvt_pk_bf16_f32 v132, -v73, -v75
    v_cvt_pk_bf16_f32 v133, -v77, -v79
    v_cvt_pk_bf16_f32 v134, -v91, -v91
    v_cvt_pk_bf16_f32 v135, -v93, -v95
    ds_write_b128 v36, v[128:131]
    ds_write_b128 v36, v[132:135] offset:8192
    v_pk_mul_f32 v[40:41], v[26:27], v[26:27] op_sel:[0,0] op_sel_hi:[1,0]
    v_pk_mul_f32 v[42:43], v[58:59], v[26:27] op_sel:[0,0] op_sel_hi:[1,0]
    v_pk_mul_f32 v[44:45], v[60:61], v[26:27] op_sel:[0,0] op_sel_hi:[1,0]
    v_pk_mul_f32 v[46:47], v[62:63], v[26:27] op_sel:[0,0] op_sel_hi:[1,0]
    v_pk_mul_f32 v[48:49], v[64:65], v[26:27] op_sel:[0,0] op_sel_hi:[1,0]
    v_pk_mul_f32 v[50:51], v[66:67], v[26:27] op_sel:[0,0] op_sel_hi:[1,0]
    v_pk_mul_f32 v[52:53], v[68:69], v[26:27] op_sel:[0,0] op_sel_hi:[1,0]
    v_pk_mul_f32 v[54:55], v[70:71], v[26:27] op_sel:[0,0] op_sel_hi:[1,0]
    v_pk_mul_f32 v[86:87], v[82:83], v[24:25] op_sel:[0,0] op_sel_hi:[1,0]
    v_pk_mul_f32 v[96:97], v[84:85], v[22:23] op_sel:[0,0] op_sel_hi:[1,0]
    v_pk_mul_f32 v[102:103], v[94:95], v[22:23] op_sel:[0,0] op_sel_hi:[1,0]
    v_pk_mul_f32 v[110:111], v[104:105], v[22:23] op_sel:[0,0] op_sel_hi:[1,0]
    v_pk_mul_f32 v[112:113], v[106:107], v[22:23] op_sel:[0,0] op_sel_hi:[1,0]
    v_pk_fma_f32 v[40:41], v[26:27], v[26:27], v[40:41] op_sel:[1,1,0] op_sel_hi:[0,1,1] neg_lo:[1,0,0]
    v_pk_fma_f32 v[42:43], v[58:59], v[26:27], v[42:43] op_sel:[1,1,0] op_sel_hi:[0,1,1] neg_lo:[1,0,0]
    v_pk_fma_f32 v[44:45], v[60:61], v[26:27], v[44:45] op_sel:[1,1,0] op_sel_hi:[0,1,1] neg_lo:[1,0,0]
    v_pk_fma_f32 v[46:47], v[62:63], v[26:27], v[46:47] op_sel:[1,1,0] op_sel_hi:[0,1,1] neg_lo:[1,0,0]
    v_pk_fma_f32 v[48:49], v[64:65], v[26:27], v[48:49] op_sel:[1,1,0] op_sel_hi:[0,1,1] neg_lo:[1,0,0]
    v_pk_fma_f32 v[50:51], v[66:67], v[26:27], v[50:51] op_sel:[1,1,0] op_sel_hi:[0,1,1] neg_lo:[1,0,0]
    v_pk_fma_f32 v[52:53], v[68:69], v[26:27], v[52:53] op_sel:[1,1,0] op_sel_hi:[0,1,1] neg_lo:[1,0,0]
    v_pk_fma_f32 v[54:55], v[70:71], v[26:27], v[54:55] op_sel:[1,1,0] op_sel_hi:[0,1,1] neg_lo:[1,0,0]
    v_pk_fma_f32 v[86:87], v[82:83], v[24:25], v[86:87] op_sel:[1,1,0] op_sel_hi:[0,1,1] neg_lo:[1,0,0]
    v_pk_fma_f32 v[96:97], v[84:85], v[22:23], v[96:97] op_sel:[1,1,0] op_sel_hi:[0,1,1] neg_lo:[1,0,0]
    v_pk_fma_f32 v[102:103], v[94:95], v[22:23], v[102:103] op_sel:[1,1,0] op_sel_hi:[0,1,1] neg_lo:[1,0,0]
    v_pk_fma_f32 v[110:111], v[104:105], v[22:23], v[110:111] op_sel:[1,1,0] op_sel_hi:[0,1,1] neg_lo:[1,0,0]
    v_pk_fma_f32 v[112:113], v[106:107], v[22:23], v[112:113] op_sel:[1,1,0] op_sel_hi:[0,1,1] neg_lo:[1,0,0]
    v_cvt_pk_bf16_f32 v136, v40, v42
    v_cvt_pk_bf16_f32 v137, v44, v46
    v_cvt_pk_bf16_f32 v138, v48, v50
    v_cvt_pk_bf16_f32 v139, v52, v54
    v_cvt_pk_bf16_f32 v140, v41, v43
    v_cvt_pk_bf16_f32 v141, v45, v47
    v_cvt_pk_bf16_f32 v142, v49, v51
    v_cvt_pk_bf16_f32 v143, v53, v55
    ds_write_b128 v34, v[136:139]
    ds_write_b128 v34, v[140:143] offset:8192
    v_cvt_pk_bf16_f32 v128, v80, v82
    v_cvt_pk_bf16_f32 v129, v84, v86
    v_cvt_pk_bf16_f32 v130, v94, v94
    v_cvt_pk_bf16_f32 v131, v96, v98
    v_cvt_pk_bf16_f32 v132, -v81, -v83
    v_cvt_pk_bf16_f32 v133, -v85, -v87
    v_cvt_pk_bf16_f32 v134, -v95, -v95
    v_cvt_pk_bf16_f32 v135, -v97, -v99
    ds_write_b128 v37, v[128:131]
    ds_write_b128 v37, v[132:135] offset:8192
    v_pk_mul_f32 v[56:57], v[40:41], v[26:27] op_sel:[0,0] op_sel_hi:[1,0]
    v_pk_mul_f32 v[58:59], v[42:43], v[26:27] op_sel:[0,0] op_sel_hi:[1,0]
    v_pk_mul_f32 v[60:61], v[44:45], v[26:27] op_sel:[0,0] op_sel_hi:[1,0]
    v_pk_mul_f32 v[62:63], v[46:47], v[26:27] op_sel:[0,0] op_sel_hi:[1,0]
    v_pk_mul_f32 v[108:109], v[102:103], v[22:23] op_sel:[0,0] op_sel_hi:[1,0]
    v_pk_mul_f32 v[114:115], v[110:111], v[22:23] op_sel:[0,0] op_sel_hi:[1,0]
    v_pk_mul_f32 v[116:117], v[112:113], v[22:23] op_sel:[0,0] op_sel_hi:[1,0]
    v_pk_fma_f32 v[56:57], v[40:41], v[26:27], v[56:57] op_sel:[1,1,0] op_sel_hi:[0,1,1] neg_lo:[1,0,0]
    v_pk_fma_f32 v[58:59], v[42:43], v[26:27], v[58:59] op_sel:[1,1,0] op_sel_hi:[0,1,1] neg_lo:[1,0,0]
    v_pk_fma_f32 v[60:61], v[44:45], v[26:27], v[60:61] op_sel:[1,1,0] op_sel_hi:[0,1,1] neg_lo:[1,0,0]
    v_pk_fma_f32 v[62:63], v[46:47], v[26:27], v[62:63] op_sel:[1,1,0] op_sel_hi:[0,1,1] neg_lo:[1,0,0]
    v_pk_fma_f32 v[108:109], v[102:103], v[22:23], v[108:109] op_sel:[1,1,0] op_sel_hi:[0,1,1] neg_lo:[1,0,0]
    v_pk_fma_f32 v[114:115], v[110:111], v[22:23], v[114:115] op_sel:[1,1,0] op_sel_hi:[0,1,1] neg_lo:[1,0,0]
    v_pk_fma_f32 v[116:117], v[112:113], v[22:23], v[116:117] op_sel:[1,1,0] op_sel_hi:[0,1,1] neg_lo:[1,0,0]
    v_pk_mul_f32 v[64:65], v[48:49], v[26:27] op_sel:[0,0] op_sel_hi:[1,0]
    v_pk_mul_f32 v[66:67], v[50:51], v[26:27] op_sel:[0,0] op_sel_hi:[1,0]
    v_pk_mul_f32 v[68:69], v[52:53], v[26:27] op_sel:[0,0] op_sel_hi:[1,0]
    v_pk_mul_f32 v[70:71], v[54:55], v[26:27] op_sel:[0,0] op_sel_hi:[1,0]
    v_pk_mul_f32 v[118:119], v[114:115], v[22:23] op_sel:[0,0] op_sel_hi:[1,0]
    v_pk_mul_f32 v[120:121], v[116:117], v[22:23] op_sel:[0,0] op_sel_hi:[1,0]
    v_pk_fma_f32 v[64:65], v[48:49], v[26:27], v[64:65] op_sel:[1,1,0] op_sel_hi:[0,1,1] neg_lo:[1,0,0]
    v_pk_fma_f32 v[66:67], v[50:51], v[26:27], v[66:67] op_sel:[1,1,0] op_sel_hi:[0,1,1] neg_lo:[1,0,0]
    v_pk_fma_f32 v[68:69], v[52:53], v[26:27], v[68:69] op_sel:[1,1,0] op_sel_hi:[0,1,1] neg_lo:[1,0,0]
    v_pk_fma_f32 v[70:71], v[54:55], v[26:27], v[70:71] op_sel:[1,1,0] op_sel_hi:[0,1,1] neg_lo:[1,0,0]
    v_pk_fma_f32 v[118:119], v[114:115], v[22:23], v[118:119] op_sel:[1,1,0] op_sel_hi:[0,1,1] neg_lo:[1,0,0]
    v_pk_fma_f32 v[120:121], v[116:117], v[22:23], v[120:121] op_sel:[1,1,0] op_sel_hi:[0,1,1] neg_lo:[1,0,0]
    v_cvt_pk_bf16_f32 v136, v56, v58
    v_cvt_pk_bf16_f32 v137, v60, v62
    v_cvt_pk_bf16_f32 v138, v64, v66
    v_cvt_pk_bf16_f32 v139, v68, v70
    v_cvt_pk_bf16_f32 v140, v57, v59
    v_cvt_pk_bf16_f32 v141, v61, v63
    v_cvt_pk_bf16_f32 v142, v65, v67
    v_cvt_pk_bf16_f32 v143, v69, v71
    ds_write_b128 v35, v[136:139]
    ds_write_b128 v35, v[140:143] offset:8192
    v_pk_mul_f32 v[122:123], v[118:119], v[22:23] op_sel:[0,0] op_sel_hi:[1,0]
    v_pk_mul_f32 v[124:125], v[120:121], v[22:23] op_sel:[0,0] op_sel_hi:[1,0]
    v_pk_fma_f32 v[122:123], v[118:119], v[22:23], v[122:123] op_sel:[1,1,0] op_sel_hi:[0,1,1] neg_lo:[1,0,0]
    v_pk_fma_f32 v[124:125], v[120:121], v[22:23], v[124:125] op_sel:[1,1,0] op_sel_hi:[0,1,1] neg_lo:[1,0,0]
    v_cvt_pk_bf16_f32 v128, v100, v102
    v_cvt_pk_bf16_f32 v129, v104, v104
    v_cvt_pk_bf16_f32 v130, v106, v108
    v_cvt_pk_bf16_f32 v131, v110, v110
    v_cvt_pk_bf16_f32 v132, -v101, -v103
    v_cvt_pk_bf16_f32 v133, -v105, -v105
    v_cvt_pk_bf16_f32 v134, -v107, -v109
    v_cvt_pk_bf16_f32 v135, -v111, -v111
    ds_write_b128 v38, v[128:131]
    ds_write_b128 v38, v[132:135] offset:8192
    v_pk_mul_f32 v[126:127], v[122:123], v[22:23] op_sel:[0,0] op_sel_hi:[1,0]
    v_pk_fma_f32 v[126:127], v[122:123], v[22:23], v[126:127] op_sel:[1,1,0] op_sel_hi:[0,1,1] neg_lo:[1,0,0]
    v_cvt_pk_bf16_f32 v136, v112, v114
    v_cvt_pk_bf16_f32 v137, v120, v122
    v_cvt_pk_bf16_f32 v138, v116, v118
    v_cvt_pk_bf16_f32 v139, v124, v126
    v_cvt_pk_bf16_f32 v140, -v113, -v115
    v_cvt_pk_bf16_f32 v141, -v121, -v123
    v_cvt_pk_bf16_f32 v142, -v117, -v119
    v_cvt_pk_bf16_f32 v143, -v125, -v127
    ds_write_b128 v39, v[136:139]
    ds_write_b128 v39, v[140:143] offset:8192
    ds_read_b64_tr_b16 v[192:193], v11 offset:0
    ds_read_b64_tr_b16 v[194:195], v11 offset:8192
    ds_read_b64_tr_b16 v[160:161], v10 offset:0
    ds_read_b64_tr_b16 v[162:163], v10 offset:8192
    ds_read_b64_tr_b16 v[196:197], v11 offset:1024
    ds_read_b64_tr_b16 v[198:199], v11 offset:9216
    ds_read_b64_tr_b16 v[164:165], v10 offset:1024
    ds_read_b64_tr_b16 v[166:167], v10 offset:9216
    ds_read_b64_tr_b16 v[200:201], v11 offset:2048
    ds_read_b64_tr_b16 v[202:203], v11 offset:10240
    ds_read_b64_tr_b16 v[168:169], v10 offset:2048
    ds_read_b64_tr_b16 v[170:171], v10 offset:10240
    s_waitcnt lgkmcnt(8)
    v_mfma_f32_32x32x16_bf16 v[144:159], v[160:163], v[192:195], v[144:159]
    ds_read_b64_tr_b16 v[204:205], v11 offset:3072
    ds_read_b64_tr_b16 v[206:207], v11 offset:11264
    ds_read_b64_tr_b16 v[172:173], v10 offset:3072
    ds_read_b64_tr_b16 v[174:175], v10 offset:11264
    s_waitcnt lgkmcnt(8)
    v_mfma_f32_32x32x16_bf16 v[144:159], v[164:167], v[196:199], v[144:159]
    ds_read_b64_tr_b16 v[208:209], v11 offset:4096
    ds_read_b64_tr_b16 v[210:211], v11 offset:12288
    ds_read_b64_tr_b16 v[176:177], v10 offset:4096
    ds_read_b64_tr_b16 v[178:179], v10 offset:12288
    s_waitcnt lgkmcnt(8)
    v_mfma_f32_32x32x16_bf16 v[144:159], v[168:171], v[200:203], v[144:159]
    ds_read_b64_tr_b16 v[212:213], v11 offset:5120
    ds_read_b64_tr_b16 v[214:215], v11 offset:13312
    ds_read_b64_tr_b16 v[180:181], v10 offset:5120
    ds_read_b64_tr_b16 v[182:183], v10 offset:13312
    s_waitcnt lgkmcnt(8)
    v_mfma_f32_32x32x16_bf16 v[144:159], v[172:175], v[204:207], v[144:159]
    ds_read_b64_tr_b16 v[216:217], v11 offset:6144
    ds_read_b64_tr_b16 v[218:219], v11 offset:14336
    ds_read_b64_tr_b16 v[184:185], v10 offset:6144
    ds_read_b64_tr_b16 v[186:187], v10 offset:14336
    s_waitcnt lgkmcnt(8)
    v_mfma_f32_32x32x16_bf16 v[144:159], v[176:179], v[208:211], v[144:159]
    ds_read_b64_tr_b16 v[220:221], v11 offset:7168
    ds_read_b64_tr_b16 v[222:223], v11 offset:15360
    ds_read_b64_tr_b16 v[188:189], v10 offset:7168
    ds_read_b64_tr_b16 v[190:191], v10 offset:15360
    s_waitcnt lgkmcnt(8)
    v_mfma_f32_32x32x16_bf16 v[144:159], v[180:183], v[212:215], v[144:159]
    s_waitcnt lgkmcnt(4)
    v_mfma_f32_32x32x16_bf16 v[144:159], v[184:187], v[216:219], v[144:159]
    s_waitcnt lgkmcnt(0)
    v_mfma_f32_32x32x16_bf16 v[144:159], v[188:191], v[220:223], v[144:159]
    s_sub_u32 s62, s62, 1
    s_cmp_lg_u32 s62, 0
    s_cbranch_scc1 KGP_206
    v_lshl_add_u32 v10, v0, 4, s84
    v_cmp_eq_u32 vcc, 0, v0
    v_and_b32 v12, 1, v0
    v_cmp_eq_u32 s[64:65], 1, v12
    v_lshlrev_b32 v9, 16, v9
    v_cndmask_b32 v9, 0, v9, vcc
    v_mov_b32 v16, 0
    v_mov_b32 v17, 0
    v_mov_b32 v18, 0
    v_mov_b32 v19, 0
    v_lshrrev_b32 v13, 3, v0
    v_mul_u32_u24 v13, 4288, v13
    v_and_b32 v14, 7, v0
    v_lshl_add_u32 v13, v14, 4, v13
    v_add_u32 v13, s84, v13
    s_mov_b64 exec, 0x7f7f7f7f
    ds_write_b128 v13, v[16:19]
    s_mov_b64 exec, -1
    v_add_f32 v144, v144, v9
    v_cndmask_b32 v14, v156, v157, s[64:65]
    v_cndmask_b32 v15, v158, v159, s[64:65]
    v_cvt_pk_bf16_f32 v36, v144, v145
    v_cvt_pk_bf16_f32 v37, v146, v147
    v_cvt_pk_bf16_f32 v38, v148, v149
    v_cvt_pk_bf16_f32 v39, v150, v151
    ds_write_b128 v10, v[36:39] offset:12976
    ds_read_b128 v[32:35], v10 offset:12960
    v_cvt_pk_bf16_f32 v44, v152, v152
    v_cvt_pk_bf16_f32 v45, v152, v153
    v_cvt_pk_bf16_f32 v46, v153, v153
    v_cvt_pk_bf16_f32 v47, v154, v154
    ds_write_b128 v10, v[44:47] offset:14000
    ds_read_b128 v[40:43], v10 offset:13984
    v_cvt_pk_bf16_f32 v52, v156, v156
    v_cvt_pk_bf16_f32 v53, v156, v156
    v_cvt_pk_bf16_f32 v54, v14, v157
    v_cvt_pk_bf16_f32 v55, v157, v157
    ds_write_b128 v10, v[52:55] offset:15024
    ds_read_b128 v[48:51], v10 offset:15008
    v_cvt_pk_bf16_f32 v60, v158, v158
    v_cvt_pk_bf16_f32 v61, v158, v158
    v_cvt_pk_bf16_f32 v62, v15, v159
    v_cvt_pk_bf16_f32 v63, v159, v159
    ds_write_b128 v10, v[60:63] offset:16048
    ds_read_b128 v[56:59], v10 offset:16032
    s_waitcnt lgkmcnt(6)
    v_alignbit_b32 v64, v34, v33, 16
    v_alignbit_b32 v65, v35, v34, 16
    v_alignbit_b32 v66, v36, v35, 16
    v_alignbit_b32 v67, v37, v36, 16
    v_alignbit_b32 v68, v38, v37, 16
    v_alignbit_b32 v69, v39, v38, 16
    ds_write_b128 v10, v[34:37] offset:4400
    ds_write_b128 v10, v[64:67] offset:112
    ds_write_b128 v10, v[66:69] offset:8688
    s_waitcnt lgkmcnt(7)
    v_alignbit_b32 v72, v42, v41, 16
    v_alignbit_b32 v73, v43, v42, 16
    v_alignbit_b32 v74, v44, v43, 16
    v_alignbit_b32 v75, v45, v44, 16
    v_alignbit_b32 v76, v46, v45, 16
    v_alignbit_b32 v77, v47, v46, 16
    ds_write_b128 v10, v[42:45] offset:5424
    ds_write_b128 v10, v[72:75] offset:1136
    ds_write_b128 v10, v[74:77] offset:9712
    s_waitcnt lgkmcnt(8)
    v_alignbit_b32 v80, v50, v49, 16
    v_alignbit_b32 v81, v51, v50, 16
    v_alignbit_b32 v82, v52, v51, 16
    v_alignbit_b32 v83, v53, v52, 16
    v_alignbit_b32 v84, v54, v53, 16
    v_alignbit_b32 v85, v55, v54, 16
    ds_write_b128 v10, v[50:53] offset:6448
    ds_write_b128 v10, v[80:83] offset:2160
    ds_write_b128 v10, v[82:85] offset:10736
    s_waitcnt lgkmcnt(9)
    v_alignbit_b32 v88, v58, v57, 16
    v_alignbit_b32 v89, v59, v58, 16
    v_alignbit_b32 v90, v60, v59, 16
    v_alignbit_b32 v91, v61, v60, 16
    v_alignbit_b32 v92, v62, v61, 16
    v_alignbit_b32 v93, v63, v62, 16
    ds_write_b128 v10, v[58:61] offset:7472
    ds_write_b128 v10, v[88:91] offset:3184
    ds_write_b128 v10, v[90:93] offset:11760
    s_setprio 3
    s_waitcnt lgkmcnt(0)
    v_mov_b32 v254, 163776
    v_mov_b32 v255, 1
    s_mov_b64 exec, 1
    ds_add_u32 v254, v255
    s_mov_b64 exec, -1
K_CV:
    s_add_u32 s48, s40, 4980736
    s_addc_u32 s49, s41, 0
    s_mov_b32 s50, 2359296
    s_mov_b32 s51, 0x20000
    s_waitcnt vmcnt(0)
    v_and_b32 v4, 3, v0
    v_mul_u32_u24 v8, 4288, v4
    v_bfe_u32 v4, v0, 2, 2
    v_lshrrev_b32 v5, 4, v0
    v_add3_u32 v4, v4, v5, 4
    v_lshl_add_u32 v8, v4, 4, v8
    v_bfe_u32 v4, v0, 1, 3
    v_lshlrev_b32 v4, 2, v4
    v_sub_u32 v4, v5, v4
    v_add_u32 v4, 28, v4
    v_and_b32 v5, 1, v0
    v_xor_b32 v5, 1, v5
    v_mul_u32_u24 v9, 4640, v5
    v_lshl_add_u32 v9, v4, 4, v9
    v_lshlrev_b32 v10, 3, v0
    s_lshr_b32 s60, s3, 1
    s_mul_i32 s84, s60, 17408
    s_add_u32 s84, s84, 111488
    s_mul_i32 s83, s60, 9280
    s_add_u32 s83, s83, 56832
    s_add_u32 s85, s80, s60
    s_andn2_b32 s86, 1, s3
    s_mov_b32 s87, 15
    s_lshl_b32 s60, s4, 3
    s_add_u32 s60, s60, s5
    s_lshl_b32 s60, s60, 7
    s_add_u32 s60, s60, 229376
    v_lshl_add_u32 v247, v0, 2, s60
    s_mov_b32 s88, s42
    v_mov_b32 v254, 163776
    s_mov_b32 s91, 3200000
LW_207:
    ds_read_b32 v255, v254
    s_waitcnt lgkmcnt(0)
    v_readfirstlane_b32 s90, v255
    s_sub_u32 s91, s91, 1
    s_cbranch_scc1 LWD_208
    s_cmp_ge_u32 s90, s79
    s_cbranch_scc1 LWD_208
    s_sleep 4
    s_branch LW_207
LWD_208:
K_CVJ:
    v_add_u32 v2, s84, v8
    s_xor_b32 s60, s86, 1
    s_lshl_b32 s60, s60, 9
    s_add_u32 s61, s60, s83
    v_add_u32 v3, s61, v9
    s_mov_b32 s61, 4
    ds_read_b128 v[32:35], v2 offset:0
    ds_read_b128 v[64:67], v3 offset:3584
    ds_read_b128 v[36:39], v2 offset:512
    ds_read_b128 v[68:71], v3 offset:3072
    s_waitcnt lgkmcnt(4)
    ds_read_b128 v[40:43], v2 offset:1024
    ds_read_b128 v[72:75], v3 offset:2560
    ds_read_b128 v[44:47], v2 offset:1536
    ds_read_b128 v[76:79], v3 offset:2048
    s_waitcnt lgkmcnt(4)
    ds_read_b128 v[48:51], v2 offset:2048
    ds_read_b128 v[80:83], v3 offset:1536
    ds_read_b128 v[52:55], v2 offset:2560
    ds_read_b128 v[84:87], v3 offset:1024
    s_waitcnt lgkmcnt(4)
    ds_read_b128 v[56:59], v2 offset:3072
    ds_read_b128 v[88:91], v3 offset:512
    ds_read_b128 v[60:63], v2 offset:3584
    ds_read_b128 v[92:95], v3 offset:0
    s_waitcnt lgkmcnt(4)
    v_mov_b32 v16, 0
    v_mov_b32 v17, 0
    v_mov_b32 v18, 0
    v_mov_b32 v19, 0
    v_mov_b32 v20, 0
    v_mov_b32 v21, 0
    v_mov_b32 v22, 0
    v_mov_b32 v23, 0
    v_mov_b32 v24, 0
    v_mov_b32 v25, 0
    v_mov_b32 v26, 0
    v_mov_b32 v27, 0
    v_mov_b32 v28, 0
    v_mov_b32 v29, 0
    v_mov_b32 v30, 0
    v_mov_b32 v31, 0
    s_cmp_lg_u32 s87, 15
    s_cbranch_scc1 CVL_209
    s_setprio 0
CVL_209:
    s_waitcnt lgkmcnt(0)
    ds_read_b128 v[96:99], v2 offset:64
    ds_read_b128 v[128:131], v3 offset:3648
    ds_read_b128 v[100:103], v2 offset:576
    ds_read_b128 v[132:135], v3 offset:3136
    ds_read_b128 v[104:107], v2 offset:1088
    ds_read_b128 v[136:139], v3 offset:2624
    ds_read_b128 v[108:111], v2 offset:1600
    ds_read_b128 v[140:143], v3 offset:2112
    ds_read_b128 v[112:115], v2 offset:2112
    ds_read_b128 v[144:147], v3 offset:1600
    ds_read_b128 v[116:119], v2 offset:2624
    ds_read_b128 v[148:151], v3 offset:1088
    ds_read_b128 v[120:123], v2 offset:3136
    ds_read_b128 v[152:155], v3 offset:576
    ds_read_b128 v[124:127], v2 offset:3648
    ds_read_b128 v[156:159], v3 offset:64
    s_bitcmp0_b32 s87, 3
    s_cbranch_scc1 CVS_210
    v_mfma_f32_16x16x32_bf16 v[28:31], v[32:35], v[92:95], v[28:31]
    v_mfma_f32_16x16x32_bf16 v[28:31], v[36:39], v[88:91], v[28:31]
    v_mfma_f32_16x16x32_bf16 v[28:31], v[40:43], v[84:87], v[28:31]
    v_mfma_f32_16x16x32_bf16 v[28:31], v[44:47], v[80:83], v[28:31]
    v_mfma_f32_16x16x32_bf16 v[28:31], v[48:51], v[76:79], v[28:31]
    v_mfma_f32_16x16x32_bf16 v[28:31], v[52:55], v[72:75], v[28:31]
    v_mfma_f32_16x16x32_bf16 v[28:31], v[56:59], v[68:71], v[28:31]
    s_cmp_eq_u32 s86, 0
    s_cbranch_scc1 CVS_210
    v_mfma_f32_16x16x32_bf16 v[28:31], v[60:63], v[64:67], v[28:31]
CVS_210:
    s_bitcmp0_b32 s87, 2
    s_cbranch_scc1 CVS_211
    v_mfma_f32_16x16x32_bf16 v[24:27], v[32:35], v[84:87], v[24:27]
    v_mfma_f32_16x16x32_bf16 v[24:27], v[36:39], v[80:83], v[24:27]
    v_mfma_f32_16x16x32_bf16 v[24:27], v[40:43], v[76:79], v[24:27]
    v_mfma_f32_16x16x32_bf16 v[24:27], v[44:47], v[72:75], v[24:27]
    v_mfma_f32_16x16x32_bf16 v[24:27], v[48:51], v[68:71], v[24:27]
    s_cmp_eq_u32 s86, 0
    s_cbranch_scc1 CVS_211
    v_mfma_f32_16x16x32_bf16 v[24:27], v[52:55], v[64:67], v[24:27]
CVS_211:
    s_bitcmp0_b32 s87, 1
    s_cbranch_scc1 CVS_212
    v_mfma_f32_16x16x32_bf16 v[20:23], v[32:35], v[76:79], v[20:23]
    v_mfma_f32_16x16x32_bf16 v[20:23], v[36:39], v[72:75], v[20:23]
    v_mfma_f32_16x16x32_bf16 v[20:23], v[40:43], v[68:71], v[20:23]
    s_cmp_eq_u32 s86, 0
    s_cbranch_scc1 CVS_212
    v_mfma_f32_16x16x32_bf16 v[20:23], v[44:47], v[64:67], v[20:23]
CVS_212:
    s_bitcmp0_b32 s87, 0
    s_cbranch_scc1 CVS_213
    v_mfma_f32_16x16x32_bf16 v[16:19], v[32:35], v[68:71], v[16:19]
    s_cmp_eq_u32 s86, 0
    s_cbranch_scc1 CVS_213
    v_mfma_f32_16x16x32_bf16 v[16:19], v[36:39], v[64:67], v[16:19]
CVS_213:
    s_waitcnt lgkmcnt(0)
    ds_read_b128 v[32:35], v2 offset:128
    ds_read_b128 v[64:67], v3 offset:3712
    ds_read_b128 v[36:39], v2 offset:640
    ds_read_b128 v[68:71], v3 offset:3200
    ds_read_b128 v[40:43], v2 offset:1152
    ds_read_b128 v[72:75], v3 offset:2688
    ds_read_b128 v[44:47], v2 offset:1664
    ds_read_b128 v[76:79], v3 offset:2176
    ds_read_b128 v[48:51], v2 offset:2176
    ds_read_b128 v[80:83], v3 offset:1664
    ds_read_b128 v[52:55], v2 offset:2688
    ds_read_b128 v[84:87], v3 offset:1152
    ds_read_b128 v[56:59], v2 offset:3200
    ds_read_b128 v[88:91], v3 offset:640
    ds_read_b128 v[60:63], v2 offset:3712
    ds_read_b128 v[92:95], v3 offset:128
    s_bitcmp0_b32 s87, 3
    s_cbranch_scc1 CVS_214
    v_mfma_f32_16x16x32_bf16 v[28:31], v[96:99], v[156:159], v[28:31]
    v_mfma_f32_16x16x32_bf16 v[28:31], v[100:103], v[152:155], v[28:31]
    v_mfma_f32_16x16x32_bf16 v[28:31], v[104:107], v[148:151], v[28:31]
    v_mfma_f32_16x16x32_bf16 v[28:31], v[108:111], v[144:147], v[28:31]
    v_mfma_f32_16x16x32_bf16 v[28:31], v[112:115], v[140:143], v[28:31]
    v_mfma_f32_16x16x32_bf16 v[28:31], v[116:119], v[136:139], v[28:31]
    v_mfma_f32_16x16x32_bf16 v[28:31], v[120:123], v[132:135], v[28:31]
    s_cmp_eq_u32 s86, 0
    s_cbranch_scc1 CVS_214
    v_mfma_f32_16x16x32_bf16 v[28:31], v[124:127], v[128:131], v[28:31]
CVS_214:
    s_bitcmp0_b32 s87, 2
    s_cbranch_scc1 CVS_215
    v_mfma_f32_16x16x32_bf16 v[24:27], v[96:99], v[148:151], v[24:27]
    v_mfma_f32_16x16x32_bf16 v[24:27], v[100:103], v[144:147], v[24:27]
    v_mfma_f32_16x16x32_bf16 v[24:27], v[104:107], v[140:143], v[24:27]
    v_mfma_f32_16x16x32_bf16 v[24:27], v[108:111], v[136:139], v[24:27]
    v_mfma_f32_16x16x32_bf16 v[24:27], v[112:115], v[132:135], v[24:27]
    s_cmp_eq_u32 s86, 0
    s_cbranch_scc1 CVS_215
    v_mfma_f32_16x16x32_bf16 v[24:27], v[116:119], v[128:131], v[24:27]
CVS_215:
    s_bitcmp0_b32 s87, 1
    s_cbranch_scc1 CVS_216
    v_mfma_f32_16x16x32_bf16 v[20:23], v[96:99], v[140:143], v[20:23]
    v_mfma_f32_16x16x32_bf16 v[20:23], v[100:103], v[136:139], v[20:23]
    v_mfma_f32_16x16x32_bf16 v[20:23], v[104:107], v[132:135], v[20:23]
    s_cmp_eq_u32 s86, 0
    s_cbranch_scc1 CVS_216
    v_mfma_f32_16x16x32_bf16 v[20:23], v[108:111], v[128:131], v[20:23]
CVS_216:
    s_bitcmp0_b32 s87, 0
    s_cbranch_scc1 CVS_217
    v_mfma_f32_16x16x32_bf16 v[16:19], v[96:99], v[132:135], v[16:19]
    s_cmp_eq_u32 s86, 0
    s_cbranch_scc1 CVS_217
    v_mfma_f32_16x16x32_bf16 v[16:19], v[100:103], v[128:131], v[16:19]
CVS_217:
    v_add_u32 v2, 128, v2
    v_add_u32 v3, 128, v3
    s_sub_u32 s61, s61, 1
    s_cmp_lg_u32 s61, 0
    s_cbranch_scc1 CVL_209
    s_setprio 3
    s_lshl_b32 s61, s85, 12
    s_lshl_b32 s60, s86, 9
    s_add_u32 s60, s60, s61
    s_waitcnt lgkmcnt(0)
    s_bitcmp0_b32 s87, 0
    s_cbranch_scc1 CVT_218
    v_cvt_pk_bf16_f32 v32, v16, v17
    v_cvt_pk_bf16_f32 v33, v18, v19
    buffer_store_dwordx2 v[32:33], v10, s[48:51], s60 offen offset:0 sc1
CVT_218:
    s_bitcmp0_b32 s87, 1
    s_cbranch_scc1 CVT_219
    v_cvt_pk_bf16_f32 v34, v20, v21
    v_cvt_pk_bf16_f32 v35, v22, v23
    buffer_store_dwordx2 v[34:35], v10, s[48:51], s60 offen offset:1024 sc1
CVT_219:
    s_bitcmp0_b32 s87, 2
    s_cbranch_scc1 CVT_220
    v_cvt_pk_bf16_f32 v36, v24, v25
    v_cvt_pk_bf16_f32 v37, v26, v27
    buffer_store_dwordx2 v[36:37], v10, s[48:51], s60 offen offset:2048 sc1
CVT_220:
    s_bitcmp0_b32 s87, 3
    s_cbranch_scc1 CVT_221
    v_cvt_pk_bf16_f32 v38, v28, v29
    v_cvt_pk_bf16_f32 v39, v30, v31
    buffer_store_dwordx2 v[38:39], v10, s[48:51], s60 offen offset:3072 sc1
CVT_221:
    s_mov_b32 s84, 146304
    s_mov_b32 s83, 75392
    s_mov_b32 s85, s82
    s_lshr_b32 s86, s43, 3
    s_lshl_b32 s87, s3, 2
    s_lshr_b32 s87, 0x4182, s87
    s_and_b32 s87, s87, 15
    s_cmp_eq_u32 s88, 0
    s_mov_b32 s88, 1
    s_cbranch_scc1 K_CVJ
    s_waitcnt vmcnt(0)
    v_mov_b32 v254, 163788
    s_mov_b32 s91, 3200000
LW_222:
    ds_read_b32 v255, v254
    s_waitcnt lgkmcnt(0)
    v_readfirstlane_b32 s90, v255
    s_sub_u32 s91, s91, 1
    s_cbranch_scc1 LWD_223
    s_cmp_ge_u32 s90, 6
    s_cbranch_scc1 LWD_223
    s_sleep 4
    s_branch LW_222
LWD_223:
    v_mov_b32 v254, 163796
    v_mov_b32 v255, 1
    s_mov_b64 exec, 1
    ds_add_rtn_u32 v255, v254, v255
    s_mov_b64 exec, -1
    s_waitcnt lgkmcnt(0)
    v_readfirstlane_b32 s60, v255
    s_cmp_lg_u32 s60, 3
    s_cbranch_scc1 LA_224
    s_add_u32 s60, s6, 8
    s_add_u32 s62, s6, 32
    s_lshl_b32 s90, s60, 7
    s_add_u32 s90, s90, 196608
    s_add_u32 s74, s40, s90
    s_addc_u32 s75, s41, 0
    s_mov_b32 s89, 1
    s_atomic_add s89, s[74:75], 0 glc
    s_lshl_b32 s90, s62, 7
    s_add_u32 s90, s90, 196608
    v_lshl_add_u32 v254, v0, 7, s90
    v_mov_b32 v255, 1
    s_waitcnt lgkmcnt(0)
    s_cmp_lg_u32 s89, 31
    s_cbranch_scc1 GA_225
    s_mov_b32 exec_lo, 0x1
    s_mov_b32 exec_hi, 0
    global_atomic_add v254, v255, s[40:41] sc1
    s_mov_b64 exec, -1
GA_225:
LA_224:
    v_mov_b32 v254, 163796
    s_mov_b32 s91, 3200000
LW_226:
    ds_read_b32 v255, v254
    s_waitcnt lgkmcnt(0)
    v_readfirstlane_b32 s90, v255
    s_sub_u32 s91, s91, 1
    s_cbranch_scc1 LWD_227
    s_cmp_ge_u32 s90, 4
    s_cbranch_scc1 LWD_227
    s_sleep 8
    s_branch LW_226
LWD_227:
    s_mov_b32 s48, s16
    s_mov_b32 s49, s17
    s_mov_b32 s50, 663552
    s_mov_b32 s51, 0x20000
    v_mul_u32_u24 v4, 6554, v0
    v_lshrrev_b32 v4, 16, v4
    v_mul_u32_u24 v5, 10, v4
    v_sub_u32 v5, v0, v5
    v_min_u32 v5, 8, v5
    v_mul_u32_u24 v4, 1152, v4
    v_lshl_add_u32 v4, v5, 4, v4
    s_sub_u32 s60, s3, s5
    s_and_b32 s60, s60, 3
    s_mul_i32 s60, s60, 11520
    s_add_u32 m0, s60, 56832
    s_mul_i32 s62, s3, 82944
    s_mul_i32 s61, s5, 144
    s_add_u32 s62, s62, s61
    s_mov_b32 s63, 0
    s_mov_b32 exec_hi, 0x0fffffff
WOD_228:
    buffer_load_dwordx4 v4, s[48:51], s62 offen lds
    s_add_u32 m0, m0, 960
    s_add_u32 s62, s62, 6912
    buffer_load_dwordx4 v4, s[48:51], s62 offen lds
    s_add_u32 m0, m0, 960
    s_add_u32 s62, s62, 6912
    buffer_load_dwordx4 v4, s[48:51], s62 offen lds
    s_add_u32 m0, m0, 960
    s_add_u32 s62, s62, 6912
    buffer_load_dwordx4 v4, s[48:51], s62 offen lds
    s_add_u32 m0, m0, 960
    s_add_u32 s62, s62, 6912
    s_add_u32 s63, s63, 1
    s_cmp_lg_u32 s63, 3
    s_cbranch_scc1 WOE_229
    s_add_u32 m0, m0, 34560
    s_add_u32 s62, s62, 248832
WOE_229:
    s_waitcnt vmcnt(6)
    s_cmp_lt_u32 s63, 6
    s_cbranch_scc1 WOD_228
    s_mov_b32 exec_hi, -1
    s_cmp_lg_u32 s3, 0
    s_cbranch_scc1 K_YO
    s_add_u32 s62, s6, 32
    s_lshl_b32 s90, s62, 7
    s_add_u32 s90, s90, 196608
    v_and_b32 v10, 0, v0
    v_lshl_add_u32 v10, v10, 7, s90
    s_mov_b64 exec, 1
    global_load_dword v11, v10, s[40:41] sc1
    s_mov_b64 exec, -1
    s_mov_b32 s91, 400000
    s_mov_b64 exec, 1
GP_230:
    s_waitcnt vmcnt(0)
    v_cmp_ne_u32 vcc, 1, v11
    s_cbranch_vccz GPD_231
    s_sub_u32 s91, s91, 1
    s_cbranch_scc1 GPD_231
    s_sleep 8
    global_load_dword v11, v10, s[40:41] sc1
    s_branch GP_230
GPD_231:
    s_mov_b64 exec, -1
    v_mov_b32 v254, 163800
    v_mov_b32 v255, 1
    s_mov_b64 exec, 1
    ds_add_u32 v254, v255
    s_mov_b64 exec, -1
    s_mov_b64 exec, 0xff
    global_load_dword v11, v247, s[40:41] offset:32 sc1
    s_getreg_b32 s61, hwreg(HW_REG_XCC_ID, 0, 8)
    s_add_u32 s61, s61, 2
    s_waitcnt vmcnt(0)
    v_cmp_ne_u32 vcc, s61, v11
    s_mov_b64 exec, -1
    s_cbranch_vccnz K_YO
    v_mov_b32 v254, 163792
    v_mov_b32 v255, 1
    s_mov_b64 exec, 1
    ds_add_u32 v254, v255
    s_mov_b64 exec, -1
K_YO:
    s_waitcnt vmcnt(0)
    v_mov_b32 v254, 163800
    v_mov_b32 v255, 1
    s_mov_b64 exec, 1
    ds_add_u32 v254, v255
    s_mov_b64 exec, -1
    s_add_u32 s52, s40, 4980736
    s_addc_u32 s53, s41, 0
    s_mov_b32 s54, 2359296
    s_mov_b32 s55, 0x20000
    v_lshrrev_b32 v12, 3, v0
    v_lshlrev_b32 v12, 12, v12
    v_bfe_u32 v13, v0, 1, 2
    v_lshl_add_u32 v12, v13, 7, v12
    v_and_b32 v13, 1, v0
    v_lshl_add_u32 v12, v13, 4, v12
    s_mul_i32 s60, s6, 72
    s_lshl_b32 s61, s3, 3
    s_add_u32 s60, s60, s61
    s_lshl_b32 s60, s60, 12
    s_lshr_b32 s61, s7, 2
    s_lshl_b32 s61, s61, 9
    s_add_u32 s60, s60, s61
    s_and_b32 s61, s7, 3
    s_lshl_b32 s61, s61, 5
    s_add_u32 s60, s60, s61
    v_mov_b32 v254, 163800
    s_mov_b32 s91, 3200000
LW_232:
    ds_read_b32 v255, v254
    s_waitcnt lgkmcnt(0)
    v_readfirstlane_b32 s90, v255
    s_sub_u32 s91, s91, 1
    s_cbranch_scc1 LWD_233
    s_cmp_ge_u32 s90, 5
    s_cbranch_scc1 LWD_233
    s_sleep 2
    s_branch LW_232
LWD_233:
    s_lshl_b32 s61, s3, 10
    s_add_u32 m0, s61, 148992
    s_nop 0
    buffer_load_dwordx4 v12, s[52:55], s60 offen sc1 lds
    s_add_u32 m0, m0, 4096
    s_add_u32 s60, s60, 131072
    buffer_load_dwordx4 v12, s[52:55], s60 offen sc1 lds
    s_cmp_lg_u32 s3, 0
    s_cbranch_scc1 YOD_234
    s_add_u32 m0, m0, 4096
    s_add_u32 s60, s60, 131072
    buffer_load_dwordx4 v12, s[52:55], s60 offen sc1 lds
YOD_234:
    s_and_b32 s95, s5, 4
    s_xor_b32 s95, s95, s3
    s_lshr_b32 s61, s95, 2
    v_bfe_u32 v8, v0, 2, 3
    v_lshrrev_b32 v9, 5, v0
    v_mul_u32_u24 v9, 18, v9
    v_add_u32 v8, v8, v9
    v_mul_u32_u24 v8, 160, v8
    s_mul_i32 s62, s61, 46080
    s_add_u32 s62, s62, 56832
    v_add_u32 v8, s62, v8
    v_lshrrev_b32 v9, 4, v0
    v_mul_u32_u24 v9, 72, v9
    v_bfe_u32 v10, v0, 3, 1
    v_mul_u32_u24 v10, 18, v10
    v_add_u32 v9, v9, v10
    v_bfe_u32 v10, v0, 2, 1
    v_add3_u32 v9, v9, v10, 16
    v_mul_u32_u24 v9, 160, v9
    v_add_u32 v9, s62, v9
    v_and_b32 v10, 3, v0
    v_lshlrev_b32 v10, 3, v10
    v_add_u32 v16, v8, v10
    v_add_u32 v19, v9, v10
    s_and_b32 s60, s95, 3
    s_lshr_b32 s61, s95, 2
    v_and_b32 v4, 15, v0
    v_lshrrev_b32 v5, 5, v0
    v_lshlrev_b32 v6, 11, v5
    v_lshl_add_u32 v6, v4, 4, v6
    v_bfe_u32 v5, v0, 4, 1
    v_lshl_add_u32 v6, v5, 9, v6
    v_lshrrev_b32 v5, 4, v0
    v_add_u32 v5, s5, v5
    v_and_b32 v5, 3, v5
    v_lshlrev_b32 v7, 10, v5
    v_lshl_add_u32 v7, v4, 2, v7
    s_lshr_b32 s62, s60, 1
    s_lshl_b32 s64, s62, 10
    s_and_b32 s63, s60, 1
    s_lshl_b32 s63, s63, 8
    s_add_u32 s64, s64, s63
    s_lshl_b32 s63, s61, 15
    s_add_u32 s64, s64, s63
    s_lshl_b32 s65, s60, 6
    s_lshl_b32 s63, s61, 12
    s_add_u32 s65, s65, s63
    s_add_u32 s65, s65, 65536
    s_add_u32 s62, s5, 0
    s_and_b32 s62, s62, 3
    s_lshl_b32 s62, s62, 13
    s_add_u32 s56, s62, s64
    s_add_u32 s57, s56, 4096
    s_add_u32 s62, s5, 1
    s_and_b32 s62, s62, 3
    s_lshl_b32 s62, s62, 13
    s_add_u32 s58, s62, s64
    s_add_u32 s59, s58, 4096
    s_add_u32 s62, s5, 2
    s_and_b32 s62, s62, 3
    s_lshl_b32 s62, s62, 13
    s_add_u32 s82, s62, s64
    s_add_u32 s83, s82, 4096
    s_add_u32 s62, s5, 3
    s_and_b32 s62, s62, 3
    s_lshl_b32 s62, s62, 13
    s_add_u32 s84, s62, s64
    s_add_u32 s85, s84, 4096
    s_mov_b32 s81, s65
    s_lshl_b32 s60, s95, 4
    v_and_b32 v4, 15, v0
    v_add_u32 v4, s60, v4
    v_mul_u32_u24 v4, 304, v4
    v_lshrrev_b32 v5, 4, v0
    v_lshl_add_u32 v244, v5, 4, v4
    v_mul_u32_u24 v4, 7282, v0
    v_lshrrev_b32 v4, 16, v4
    v_mul_u32_u24 v245, 9, v4
    v_sub_u32 v5, v0, v245
    s_lshl_b32 s60, s3, 3
    v_add_u32 v4, s60, v4
    v_mul_u32_u24 v245, 304, v4
    v_lshl_add_u32 v245, v5, 5, v245
    v_mul_u32_u24 v246, 2304, v4
    v_lshl_add_u32 v246, v5, 4, v246
    s_mul_i32 s60, s4, 147456
    s_mul_i32 s61, s5, 144
    s_add_u32 s79, s60, s61
    s_add_u32 s80, s79, 16128
    s_mov_b32 s48, s36
    s_mov_b32 s49, s37
    s_mov_b32 s50, 4718592
    s_mov_b32 s51, 0x20000
    v_mov_b32 v60, v6
    v_mov_b32 v61, v7
    s_waitcnt lgkmcnt(6)
    ds_read_b64_tr_b16 v[64:65], v16 offset:0
    ds_read_b64_tr_b16 v[66:67], v16 offset:1280
    s_waitcnt lgkmcnt(6)
    ds_read_b64_tr_b16 v[68:69], v16 offset:32
    ds_read_b64_tr_b16 v[70:71], v16 offset:1312
    s_waitcnt lgkmcnt(6)
    ds_read_b64_tr_b16 v[72:73], v16 offset:64
    ds_read_b64_tr_b16 v[74:75], v16 offset:1344
    s_waitcnt lgkmcnt(6)
    ds_read_b64_tr_b16 v[76:77], v16 offset:96
    ds_read_b64_tr_b16 v[78:79], v16 offset:1376
    s_waitcnt lgkmcnt(6)
    ds_read_b64_tr_b16 v[80:81], v16 offset:128
    ds_read_b64_tr_b16 v[82:83], v16 offset:1408
    s_waitcnt lgkmcnt(4)
    s_waitcnt lgkmcnt(6)
    ds_read_b64_tr_b16 v[84:85], v16 offset:5760
    ds_read_b64_tr_b16 v[86:87], v16 offset:7040
    s_waitcnt lgkmcnt(6)
    ds_read_b64_tr_b16 v[88:89], v16 offset:5792
    ds_read_b64_tr_b16 v[90:91], v16 offset:7072
    s_waitcnt lgkmcnt(6)
    ds_read_b64_tr_b16 v[92:93], v16 offset:5824
    ds_read_b64_tr_b16 v[94:95], v16 offset:7104
    s_waitcnt lgkmcnt(6)
    ds_read_b64_tr_b16 v[96:97], v16 offset:5856
    ds_read_b64_tr_b16 v[98:99], v16 offset:7136
    s_waitcnt lgkmcnt(6)
    ds_read_b64_tr_b16 v[100:101], v16 offset:5888
    ds_read_b64_tr_b16 v[102:103], v16 offset:7168
    s_waitcnt lgkmcnt(4)
    s_waitcnt lgkmcnt(6)
    ds_read_b64_tr_b16 v[104:105], v16 offset:11520
    ds_read_b64_tr_b16 v[106:107], v16 offset:12800
    s_waitcnt lgkmcnt(6)
    ds_read_b64_tr_b16 v[108:109], v16 offset:11552
    ds_read_b64_tr_b16 v[110:111], v16 offset:12832
    s_waitcnt lgkmcnt(6)
    ds_read_b64_tr_b16 v[112:113], v16 offset:11584
    ds_read_b64_tr_b16 v[114:115], v16 offset:12864
    s_waitcnt lgkmcnt(6)
    ds_read_b64_tr_b16 v[116:117], v16 offset:11616
    ds_read_b64_tr_b16 v[118:119], v16 offset:12896
    s_waitcnt lgkmcnt(6)
    ds_read_b64_tr_b16 v[120:121], v16 offset:11648
    ds_read_b64_tr_b16 v[122:123], v16 offset:12928
    s_waitcnt lgkmcnt(4)
    s_waitcnt lgkmcnt(6)
    ds_read_b64_tr_b16 v[124:125], v16 offset:17280
    ds_read_b64_tr_b16 v[126:127], v16 offset:18560
    s_waitcnt lgkmcnt(6)
    ds_read_b64_tr_b16 v[128:129], v16 offset:17312
    ds_read_b64_tr_b16 v[130:131], v16 offset:18592
    s_waitcnt lgkmcnt(6)
    ds_read_b64_tr_b16 v[132:133], v16 offset:17344
    ds_read_b64_tr_b16 v[134:135], v16 offset:18624
    s_waitcnt lgkmcnt(6)
    ds_read_b64_tr_b16 v[136:137], v16 offset:17376
    ds_read_b64_tr_b16 v[138:139], v16 offset:18656
    s_waitcnt lgkmcnt(6)
    ds_read_b64_tr_b16 v[140:141], v16 offset:17408
    ds_read_b64_tr_b16 v[142:143], v16 offset:18688
    s_waitcnt lgkmcnt(4)
    s_waitcnt lgkmcnt(6)
    ds_read_b64_tr_b16 v[144:145], v16 offset:23040
    ds_read_b64_tr_b16 v[146:147], v16 offset:24320
    s_waitcnt lgkmcnt(6)
    ds_read_b64_tr_b16 v[148:149], v16 offset:23072
    ds_read_b64_tr_b16 v[150:151], v16 offset:24352
    s_waitcnt lgkmcnt(6)
    ds_read_b64_tr_b16 v[152:153], v16 offset:23104
    ds_read_b64_tr_b16 v[154:155], v16 offset:24384
    s_waitcnt lgkmcnt(6)
    ds_read_b64_tr_b16 v[156:157], v16 offset:23136
    ds_read_b64_tr_b16 v[158:159], v16 offset:24416
    s_waitcnt lgkmcnt(6)
    ds_read_b64_tr_b16 v[160:161], v16 offset:23168
    ds_read_b64_tr_b16 v[162:163], v16 offset:24448
    s_waitcnt lgkmcnt(4)
    s_waitcnt lgkmcnt(6)
    ds_read_b64_tr_b16 v[164:165], v16 offset:28800
    ds_read_b64_tr_b16 v[166:167], v16 offset:30080
    s_waitcnt lgkmcnt(6)
    ds_read_b64_tr_b16 v[168:169], v16 offset:28832
    ds_read_b64_tr_b16 v[170:171], v16 offset:30112
    s_waitcnt lgkmcnt(6)
    ds_read_b64_tr_b16 v[172:173], v16 offset:28864
    ds_read_b64_tr_b16 v[174:175], v16 offset:30144
    s_waitcnt lgkmcnt(6)
    ds_read_b64_tr_b16 v[176:177], v16 offset:28896
    ds_read_b64_tr_b16 v[178:179], v16 offset:30176
    s_waitcnt lgkmcnt(6)
    ds_read_b64_tr_b16 v[180:181], v16 offset:28928
    ds_read_b64_tr_b16 v[182:183], v16 offset:30208
    s_waitcnt lgkmcnt(4)
    s_waitcnt lgkmcnt(6)
    ds_read_b64_tr_b16 v[184:185], v16 offset:34560
    ds_read_b64_tr_b16 v[186:187], v16 offset:35840
    s_waitcnt lgkmcnt(6)
    ds_read_b64_tr_b16 v[188:189], v16 offset:34592
    ds_read_b64_tr_b16 v[190:191], v16 offset:35872
    s_waitcnt lgkmcnt(6)
    ds_read_b64_tr_b16 v[192:193], v16 offset:34624
    ds_read_b64_tr_b16 v[194:195], v16 offset:35904
    s_waitcnt lgkmcnt(6)
    ds_read_b64_tr_b16 v[196:197], v16 offset:34656
    ds_read_b64_tr_b16 v[198:199], v16 offset:35936
    s_waitcnt lgkmcnt(6)
    ds_read_b64_tr_b16 v[200:201], v16 offset:34688
    ds_read_b64_tr_b16 v[202:203], v16 offset:35968
    s_waitcnt lgkmcnt(4)
    s_waitcnt lgkmcnt(6)
    ds_read_b64_tr_b16 v[204:205], v16 offset:40320
    ds_read_b64_tr_b16 v[206:207], v16 offset:41600
    s_waitcnt lgkmcnt(6)
    ds_read_b64_tr_b16 v[208:209], v16 offset:40352
    ds_read_b64_tr_b16 v[210:211], v16 offset:41632
    s_waitcnt lgkmcnt(6)
    ds_read_b64_tr_b16 v[212:213], v16 offset:40384
    ds_read_b64_tr_b16 v[214:215], v16 offset:41664
    s_waitcnt lgkmcnt(6)
    ds_read_b64_tr_b16 v[216:217], v16 offset:40416
    ds_read_b64_tr_b16 v[218:219], v16 offset:41696
    s_waitcnt lgkmcnt(6)
    ds_read_b64_tr_b16 v[220:221], v16 offset:40448
    ds_read_b64_tr_b16 v[222:223], v16 offset:41728
    s_waitcnt lgkmcnt(4)
    s_waitcnt lgkmcnt(6)
    ds_read_b64_tr_b16 v[224:225], v19 offset:0
    ds_read_b64_tr_b16 v[226:227], v19 offset:5760
    s_waitcnt lgkmcnt(6)
    ds_read_b64_tr_b16 v[228:229], v19 offset:32
    ds_read_b64_tr_b16 v[230:231], v19 offset:5792
    s_waitcnt lgkmcnt(6)
    ds_read_b64_tr_b16 v[232:233], v19 offset:64
    ds_read_b64_tr_b16 v[234:235], v19 offset:5824
    s_waitcnt lgkmcnt(6)
    ds_read_b64_tr_b16 v[236:237], v19 offset:96
    ds_read_b64_tr_b16 v[238:239], v19 offset:5856
    s_waitcnt lgkmcnt(6)
    ds_read_b64_tr_b16 v[240:241], v19 offset:128
    ds_read_b64_tr_b16 v[242:243], v19 offset:5888
    s_waitcnt lgkmcnt(4)
    s_mov_b32 s52, s36
    s_mov_b32 s53, s37
    s_mov_b32 s54, 4718592
    s_mov_b32 s55, 0x20000
    s_lshl_b32 s61, s3, 10
    v_bfe_u32 v12, v0, 2, 2
    v_lshlrev_b32 v12, 7, v12
    v_lshrrev_b32 v14, 4, v0
    v_lshl_add_u32 v12, v14, 5, v12
    v_and_b32 v13, 3, v0
    v_lshl_add_u32 v12, v13, 3, v12
    s_add_u32 s61, s61, 148992
    v_add_u32 v12, s61, v12
    v_and_b32 v13, 1, v0
    v_lshl_or_b32 v13, v14, 3, v13
    v_bfe_u32 v11, v0, 1, 1
    v_lshl_or_b32 v13, v11, 2, v13
    v_bfe_u32 v11, v0, 2, 1
    v_lshl_or_b32 v13, v11, 1, v13
    v_bfe_u32 v11, v0, 3, 1
    v_lshl_or_b32 v13, v11, 5, v13
    v_mul_u32_u24 v13, 2304, v13
    s_mul_i32 s60, s7, 147456
    s_mul_i32 s61, s6, 144
    s_add_u32 s60, s60, s61
    s_lshl_b32 s61, s3, 4
    s_add_u32 s60, s60, s61
    s_waitcnt vmcnt(0)
    ds_read_b64_tr_b16 v[20:21], v12
    ds_read_b64_tr_b16 v[22:23], v12 offset:512
    ds_read_b64_tr_b16 v[24:25], v12 offset:4096
    ds_read_b64_tr_b16 v[26:27], v12 offset:4608
    ds_read_b64_tr_b16 v[28:29], v12 offset:8192
    ds_read_b64_tr_b16 v[30:31], v12 offset:8704
    s_cmp_lg_u32 s3, 0
    s_waitcnt lgkmcnt(0)
    buffer_store_dwordx4 v[20:23], v13, s[52:55], s60 offen offset:1152
    buffer_store_dwordx4 v[24:27], v13, s[52:55], s60 offen offset:1216
    s_cbranch_scc1 YOS_235
    buffer_store_dwordx4 v[28:31], v13, s[52:55], s60 offen offset:1280
YOS_235:
    s_mul_i32 s60, s4, 73728
    s_add_u32 s60, s60, 2621440
    s_add_u32 s44, s40, s60
    s_addc_u32 s45, s41, 0
    s_mov_b32 s46, 73728
    s_mov_b32 s47, 0x20000
    s_setprio 0
    s_waitcnt lgkmcnt(0)
    s_barrier
    s_cmp_lg_u32 s3, 0
    s_cbranch_scc1 K_B6
    v_mov_b32 v254, 163784
    s_mov_b32 s91, 3200000
LW_236:
    ds_read_b32 v255, v254
    s_waitcnt lgkmcnt(0)
    v_readfirstlane_b32 s90, v255
    s_sub_u32 s91, s91, 1
    s_cbranch_scc1 LWD_237
    s_cmp_ge_u32 s90, 1
    s_cbranch_scc1 LWD_237
    s_sleep 1
    s_branch LW_236
LWD_237:
    s_mov_b64 exec, 255
    global_load_dword v11, v247, s[40:41] sc1
    s_mov_b64 exec, -1
    s_mov_b32 s91, 400000
    s_mov_b64 exec, 255
GP_238:
    s_waitcnt vmcnt(0)
    v_cmp_ne_u32 vcc, 1, v11
    s_cbranch_vccz GPD_239
    s_sub_u32 s91, s91, 1
    s_cbranch_scc1 GPD_239
    s_sleep 1
    global_load_dword v11, v247, s[40:41] sc1
    s_branch GP_238
GPD_239:
    s_mov_b64 exec, -1
K_B6:
    s_barrier
    buffer_load_dwordx4 v[24:27], v60, s[44:47], s56 offen sc1
    buffer_load_dwordx4 v[28:31], v60, s[44:47], s57 offen sc1
    buffer_load_dwordx4 v[32:35], v60, s[44:47], s58 offen sc1
    buffer_load_dwordx4 v[36:39], v60, s[44:47], s59 offen sc1
    s_branch K_OP
AC_19:
    s_mov_b32 s91, 3200000
ACS_123:
    ds_read_b32 v39, v15
    s_waitcnt lgkmcnt(0)
    v_readfirstlane_b32 s60, v39
    s_sub_u32 s91, s91, 1
    s_cbranch_scc1 AK_20
    s_cmp_lt_u32 s60, s72
    s_cbranch_scc1 ACS_123
    s_branch AK_20
ATT_SLOW:
    s_mov_b32 s62, 1
    s_waitcnt vmcnt(0) lgkmcnt(0)
    v_mov_b32 v25, 0
    v_mov_b32 v6, 0xff800000
    v_mov_b32 v7, 0xff800000
    v_and_b32 v8, 31, v0
    v_lshrrev_b32 v9, 5, v0
    v_mul_u32_u24 v9, 304, v9
    v_lshl_add_u32 v9, v8, 4, v9
    v_lshlrev_b32 v8, 2, v8
    s_mov_b32 s63, 0
    v_mov_b32 v48, 0
    v_mov_b32 v49, 0
    v_mov_b32 v50, 0
    v_mov_b32 v51, 0
    v_mov_b32 v52, 0
    v_mov_b32 v53, 0
    v_mov_b32 v54, 0
    v_mov_b32 v55, 0
    v_mov_b32 v56, 0
    v_mov_b32 v57, 0
    v_mov_b32 v58, 0
    v_mov_b32 v59, 0
    v_mov_b32 v60, 0
    v_mov_b32 v61, 0
    v_mov_b32 v62, 0
    v_mov_b32 v63, 0
    v_mov_b32 v64, 0
    v_mov_b32 v65, 0
    v_mov_b32 v66, 0
    v_mov_b32 v67, 0
    v_mov_b32 v68, 0
    v_mov_b32 v69, 0
    v_mov_b32 v70, 0
    v_mov_b32 v71, 0
    v_mov_b32 v72, 0
    v_mov_b32 v73, 0
    v_mov_b32 v74, 0
    v_mov_b32 v75, 0
    v_mov_b32 v76, 0
    v_mov_b32 v77, 0
    v_mov_b32 v78, 0
    v_mov_b32 v79, 0
ATS_P:
    s_mov_b32 s70, 0
ATS_L:
    s_lshr_b32 s64, s70, 2
    s_mul_i32 s64, s64, 9472
    s_and_b32 s65, s70, 3
    s_lshl_b32 s66, s65, 10
    s_add_u32 s66, s66, s64
    buffer_load_dwordx4 v[32:35], v26, s[52:55], s66 offen sc1
    s_lshl_b32 s66, s65, 7
    s_add_u32 s66, s66, s64
    s_add_u32 s66, s66, 4096
    buffer_load_dword v36, v8, s[52:55], s66 offen sc1
    s_mul_i32 s66, s65, 1216
    s_add_u32 s66, s66, s64
    s_add_u32 s66, s66, 4608
    buffer_load_dwordx4 v[40:43], v9, s[52:55], s66 offen sc1
    buffer_load_dwordx4 v[44:47], v9, s[52:55], s66 offen offset:608 sc1
    s_waitcnt vmcnt(0)
    v_mfma_f32_32x32x4_2b_bf16 v[80:111], v[36:37], v[24:25], 0
    s_nop 15
    s_nop 2
    v_mfma_f32_32x32x16_bf16 v[80:95], v[32:35], v[16:19], v[80:95]
    v_mfma_f32_32x32x16_bf16 v[96:111], v[32:35], v[20:23], v[96:111]
    s_nop 11
    s_cmp_lg_u32 s63, 0
    s_cbranch_scc1 ATS_B
    v_max3_f32 v6, v80, v81, v6
    v_max3_f32 v6, v82, v83, v6
    v_max3_f32 v6, v84, v85, v6
    v_max3_f32 v6, v86, v87, v6
    v_max3_f32 v6, v88, v89, v6
    v_max3_f32 v6, v90, v91, v6
    v_max3_f32 v6, v92, v93, v6
    v_max3_f32 v6, v94, v95, v6
    v_max3_f32 v7, v96, v97, v7
    v_max3_f32 v7, v98, v99, v7
    v_max3_f32 v7, v100, v101, v7
    v_max3_f32 v7, v102, v103, v7
    v_max3_f32 v7, v104, v105, v7
    v_max3_f32 v7, v106, v107, v7
    v_max3_f32 v7, v108, v109, v7
    v_max3_f32 v7, v110, v111, v7
    s_branch ATS_N
ATS_B:
    v_sub_f32 v80, v80, v6
    v_sub_f32 v81, v81, v6
    v_sub_f32 v82, v82, v6
    v_sub_f32 v83, v83, v6
    v_sub_f32 v84, v84, v6
    v_sub_f32 v85, v85, v6
    v_sub_f32 v86, v86, v6
    v_sub_f32 v87, v87, v6
    v_sub_f32 v88, v88, v6
    v_sub_f32 v89, v89, v6
    v_sub_f32 v90, v90, v6
    v_sub_f32 v91, v91, v6
    v_sub_f32 v92, v92, v6
    v_sub_f32 v93, v93, v6
    v_sub_f32 v94, v94, v6
    v_sub_f32 v95, v95, v6
    v_sub_f32 v96, v96, v7
    v_sub_f32 v97, v97, v7
    v_sub_f32 v98, v98, v7
    v_sub_f32 v99, v99, v7
    v_sub_f32 v100, v100, v7
    v_sub_f32 v101, v101, v7
    v_sub_f32 v102, v102, v7
    v_sub_f32 v103, v103, v7
    v_sub_f32 v104, v104, v7
    v_sub_f32 v105, v105, v7
    v_sub_f32 v106, v106, v7
    v_sub_f32 v107, v107, v7
    v_sub_f32 v108, v108, v7
    v_sub_f32 v109, v109, v7
    v_sub_f32 v110, v110, v7
    v_sub_f32 v111, v111, v7
    v_exp_f32 v80, v80
    v_exp_f32 v81, v81
    v_exp_f32 v82, v82
    v_exp_f32 v83, v83
    v_exp_f32 v84, v84
    v_exp_f32 v85, v85
    v_exp_f32 v86, v86
    v_exp_f32 v87, v87
    v_exp_f32 v88, v88
    v_exp_f32 v89, v89
    v_exp_f32 v90, v90
    v_exp_f32 v91, v91
    v_exp_f32 v92, v92
    v_exp_f32 v93, v93
    v_exp_f32 v94, v94
    v_exp_f32 v95, v95
    v_exp_f32 v96, v96
    v_exp_f32 v97, v97
    v_exp_f32 v98, v98
    v_exp_f32 v99, v99
    v_exp_f32 v100, v100
    v_exp_f32 v101, v101
    v_exp_f32 v102, v102
    v_exp_f32 v103, v103
    v_exp_f32 v104, v104
    v_exp_f32 v105, v105
    v_exp_f32 v106, v106
    v_exp_f32 v107, v107
    v_exp_f32 v108, v108
    v_exp_f32 v109, v109
    v_exp_f32 v110, v110
    v_exp_f32 v111, v111
    s_nop 1
    v_smfmac_f32_32x32x32_bf16 v[48:63], v[40:43], v[80:87], v28
    v_smfmac_f32_32x32x32_bf16 v[48:63], v[44:47], v[88:95], v28
    v_smfmac_f32_32x32x32_bf16 v[64:79], v[40:43], v[96:103], v28
    v_smfmac_f32_32x32x32_bf16 v[64:79], v[44:47], v[104:111], v28
ATS_N:
    s_add_u32 s70, s70, 1
    s_cmp_lt_u32 s70, 64
    s_cbranch_scc1 ATS_L
    s_cmp_lg_u32 s63, 0
    s_cbranch_scc1 ALC_22
    s_mov_b32 s63, 1
    v_mov_b32 v10, v6
    v_mov_b32 v11, v7
    s_nop 1
    v_permlane32_swap_b32 v6, v10
    v_permlane32_swap_b32 v7, v11
    v_max_f32 v6, v6, v10
    v_max_f32 v7, v7, v11
    s_branch ATS_P
OF_124:
    buffer_store_dwordx4 v[4:7], v26, s[44:47], s86 offen sc1
    buffer_store_dwordx4 v[8:11], v26, s[44:47], s87 offen sc1
    buffer_store_dword v12, v27, s[44:47], s88 offen sc1
    s_cmp_lg_u32 s3, 7
    s_cbranch_scc1 MB_176
    s_mov_b64 exec, 0xff
    global_store_dword v168, v38, s[40:41] sc1
    s_mov_b64 exec, -1
MB_176:
    s_branch OJ_125
OP_S0:
    v_max3_u32 v62, v24, v25, v26
    v_max_u32 v62, v62, v27
    v_cmp_eq_u32 vcc, -1, v62
    s_cbranch_vccz OP_G0
OP_R0:
    s_sub_u32 s91, s91, 1
    s_cbranch_scc1 OP_G0
    s_mov_b32 s60, 0
    s_waitcnt vmcnt(0)
    s_sleep 6
    s_branch OP_B0
OP_S1:
    v_max3_u32 v62, v28, v29, v30
    v_max_u32 v62, v62, v31
    v_cmp_eq_u32 vcc, -1, v62
    s_cbranch_vccz OP_G1
OP_R1:
    s_sub_u32 s91, s91, 1
    s_cbranch_scc1 OP_G1
    s_mov_b32 s60, 1
    s_waitcnt vmcnt(0)
    s_sleep 6
    s_branch OP_B1
OP_S2:
    v_max3_u32 v62, v32, v33, v34
    v_max_u32 v62, v62, v35
    v_cmp_eq_u32 vcc, -1, v62
    s_cbranch_vccz OP_G2
OP_R2:
    s_sub_u32 s91, s91, 1
    s_cbranch_scc1 OP_G2
    s_mov_b32 s60, 2
    s_waitcnt vmcnt(0)
    s_sleep 6
    s_branch OP_B2
OP_S3:
    v_max3_u32 v62, v36, v37, v38
    v_max_u32 v62, v62, v39
    v_cmp_eq_u32 vcc, -1, v62
    s_cbranch_vccz OP_G3
OP_R3:
    s_sub_u32 s91, s91, 1
    s_cbranch_scc1 OP_G3
    s_mov_b32 s60, 3
    s_waitcnt vmcnt(0)
    s_sleep 6
    s_branch OP_B3
OP_S4:
    v_max3_u32 v62, v40, v41, v42
    v_max_u32 v62, v62, v43
    v_cmp_eq_u32 vcc, -1, v62
    s_cbranch_vccz OP_G4
OP_R4:
    s_sub_u32 s91, s91, 1
    s_cbranch_scc1 OP_G4
    s_mov_b32 s60, 4
    s_waitcnt vmcnt(0)
    s_sleep 6
    s_branch OP_B4
OP_S5:
    v_max3_u32 v62, v44, v45, v46
    v_max_u32 v62, v62, v47
    v_cmp_eq_u32 vcc, -1, v62
    s_cbranch_vccz OP_G5
OP_R5:
    s_sub_u32 s91, s91, 1
    s_cbranch_scc1 OP_G5
    s_mov_b32 s60, 5
    s_waitcnt vmcnt(0)
    s_sleep 6
    s_branch OP_B5
OP_S6:
    v_max3_u32 v62, v48, v49, v50
    v_max_u32 v62, v62, v51
    v_cmp_eq_u32 vcc, -1, v62
    s_cbranch_vccz OP_G6
OP_R6:
    s_sub_u32 s91, s91, 1
    s_cbranch_scc1 OP_G6
    s_mov_b32 s60, 6
    s_waitcnt vmcnt(0)
    s_sleep 6
    s_branch OP_B6
OP_S7:
    v_max3_u32 v62, v52, v53, v54
    v_max_u32 v62, v62, v55
    v_cmp_eq_u32 vcc, -1, v62
    s_cbranch_vccz OP_G7
OP_R7:
    s_sub_u32 s91, s91, 1
    s_cbranch_scc1 OP_G7
    s_mov_b32 s60, 7
    s_waitcnt vmcnt(0)
    s_sleep 6
    s_branch OP_B7
OP_S8:
    v_max3_u32 v62, v56, v57, v58
    v_max_u32 v62, v62, v59
    v_cmp_eq_u32 vcc, -1, v62
    s_cbranch_vccz OP_G8
OP_R8:
    s_sub_u32 s91, s91, 1
    s_cbranch_scc1 OP_G8
    s_mov_b32 s60, 8
    s_waitcnt vmcnt(0)
    s_sleep 6
    s_branch OP_B8
OP_B0:
    v_max3_u32 v62, v24, v25, v26
    v_max_u32 v62, v62, v27
    v_cmp_eq_u32 vcc, -1, v62
    s_cbranch_vccz OP_B1
    buffer_load_dwordx4 v[24:27], v60, s[44:47], s56 offen sc1
OP_B1:
    v_max3_u32 v62, v28, v29, v30
    v_max_u32 v62, v62, v31
    v_cmp_eq_u32 vcc, -1, v62
    s_cbranch_vccz OP_B2
    buffer_load_dwordx4 v[28:31], v60, s[44:47], s57 offen sc1
OP_B2:
    v_max3_u32 v62, v32, v33, v34
    v_max_u32 v62, v62, v35
    v_cmp_eq_u32 vcc, -1, v62
    s_cbranch_vccz OP_B3
    buffer_load_dwordx4 v[32:35], v60, s[44:47], s58 offen sc1
OP_B3:
    v_max3_u32 v62, v36, v37, v38
    v_max_u32 v62, v62, v39
    v_cmp_eq_u32 vcc, -1, v62
    s_cbranch_vccz OP_B4
    buffer_load_dwordx4 v[36:39], v60, s[44:47], s59 offen sc1
OP_B4:
    v_max3_u32 v62, v40, v41, v42
    v_max_u32 v62, v62, v43
    v_cmp_eq_u32 vcc, -1, v62
    s_cbranch_vccz OP_B5
    buffer_load_dwordx4 v[40:43], v60, s[44:47], s82 offen sc1
OP_B5:
    v_max3_u32 v62, v44, v45, v46
    v_max_u32 v62, v62, v47
    v_cmp_eq_u32 vcc, -1, v62
    s_cbranch_vccz OP_B6
    buffer_load_dwordx4 v[44:47], v60, s[44:47], s83 offen sc1
OP_B6:
    v_max3_u32 v62, v48, v49, v50
    v_max_u32 v62, v62, v51
    v_cmp_eq_u32 vcc, -1, v62
    s_cbranch_vccz OP_B7
    buffer_load_dwordx4 v[48:51], v60, s[44:47], s84 offen sc1
OP_B7:
    v_max3_u32 v62, v52, v53, v54
    v_max_u32 v62, v62, v55
    v_cmp_eq_u32 vcc, -1, v62
    s_cbranch_vccz OP_B8
    buffer_load_dwordx4 v[52:55], v60, s[44:47], s85 offen sc1
OP_B8:
    v_max3_u32 v62, v56, v57, v58
    v_max_u32 v62, v62, v59
    v_cmp_eq_u32 vcc, -1, v62
    s_cbranch_vccz OP_B9
    buffer_load_dword v56, v61, s[44:47], s81 offen offset:0 sc1
    buffer_load_dword v57, v61, s[44:47], s81 offen offset:256 sc1
    buffer_load_dword v58, v61, s[44:47], s81 offen offset:512 sc1
    buffer_load_dword v59, v61, s[44:47], s81 offen offset:768 sc1
OP_B9:
    s_waitcnt vmcnt(0)
    s_cmp_eq_u32 s60, 0
    s_cbranch_scc1 OP_S0
    s_cmp_eq_u32 s60, 1
    s_cbranch_scc1 OP_S1
    s_cmp_eq_u32 s60, 2
    s_cbranch_scc1 OP_S2
    s_cmp_eq_u32 s60, 3
    s_cbranch_scc1 OP_S3
    s_cmp_eq_u32 s60, 4
    s_cbranch_scc1 OP_S4
    s_cmp_eq_u32 s60, 5
    s_cbranch_scc1 OP_S5
    s_cmp_eq_u32 s60, 6
    s_cbranch_scc1 OP_S6
    s_cmp_eq_u32 s60, 7
    s_cbranch_scc1 OP_S7
    s_branch OP_S8
K_LAST:
    s_endpgm

.section .rodata,"a"
.p2align 6
.amdhsa_kernel concat_heads__grouped_kv_mqa__ssm_conv_s4__prompt_kernel
  .amdhsa_next_free_vgpr 256
  .amdhsa_next_free_sgpr 102
  .amdhsa_accum_offset 256
  .amdhsa_group_segment_fixed_size 0
  .amdhsa_kernarg_size 136
  .amdhsa_user_sgpr_count 2
  .amdhsa_user_sgpr_kernarg_segment_ptr 1
  .amdhsa_system_sgpr_workgroup_id_x 1
.end_amdhsa_kernel
```
